```python
import torch

def _softmax(x, axis=-1):
    return torch.softmax(x, dim=axis)
def _gelu(x):
    return torch.nn.functional.gelu(x, approximate="tanh")
def _silu(x):
    return torch.nn.functional.silu(x)
def _sigmoid(x):
    return torch.sigmoid(x)
def _layernorm(x, axis=-1, eps=1e-5):
    m = x.mean(dim=axis, keepdim=True)
    v = x.var(dim=axis, keepdim=True, unbiased=False)
    return (x - m) / torch.sqrt(v + eps)
def _scatter_add(tgt, idx, src, axis=0):
    return tgt.clone().index_add_(axis, idx, src)
def _segment_sum(src, seg, n):
    out = torch.zeros((n,) + src.shape[1:], dtype=src.dtype)
    return out.index_add_(0, seg, src)
def _pad(x, pw):
    flat = tuple(v for pair in reversed(pw) for v in pair)
    return torch.nn.functional.pad(x, flat)

kernel_name = 'gated_mix__ssm_conv_h3__dense_activation_silu__prompt'

def setup_inputs():

    _w = (lambda a: (lambda t: t.to(torch.bfloat16) if t.is_floating_point() else t)(torch.as_tensor(a)))
    def _A_setup():
        B, S, D = 1, 2048, 512
        ks = 4
        return {
            "q": _w((lambda *s: torch.randn(*s, dtype=torch.bfloat16) * 0.05)(B, S, D)),
            "k": _w((lambda *s: torch.randn(*s, dtype=torch.bfloat16) * 0.2)(B, S, D)),
            "v": _w((lambda *s: torch.randn(*s, dtype=torch.bfloat16) * 0.2)(B, S, D)),
            "shift_k": _w((lambda *s: torch.randn(*s, dtype=torch.bfloat16) * 0.2)(D, ks) * 0.5),
            "ssm_k": _w((lambda *s: torch.randn(*s, dtype=torch.bfloat16) * 0.4)(D, S) * (1.0 / S ** 0.5)),
            "ssm_D": _w((lambda *s: torch.randn(*s, dtype=torch.bfloat16) * 0.2)(D)),
        }
    _A_in = _A_setup()

    def _B_setup():
        B, S, D, F = 1, 2048, 512, 1792
        return {
            "x": _w((lambda *s: torch.randn(*s, dtype=torch.bfloat16) * 0.05)(B, S, D)),
            "w1": _w((lambda *s: torch.randn(*s, dtype=torch.bfloat16) * 3.2)(D, F) * (D ** -0.5)),
            "w2": _w((lambda *s: torch.randn(*s, dtype=torch.bfloat16) * 0.05)(F, D) * (F ** -0.5)),
        }
    _B_in = _B_setup()

    return {
        "A_q": _A_in["q"],
        "A_k": _A_in["k"],
        "A_v": _A_in["v"],
        "A_shift_k": _A_in["shift_k"],
        "A_ssm_k": _A_in["ssm_k"],
        "A_ssm_D": _A_in["ssm_D"],
        "B_x": _B_in["x"],
        "B_w1": _B_in["w1"],
        "B_w2": _B_in["w2"],
        "gate_w": _w((lambda *s: torch.randn(*s, dtype=torch.bfloat16) * 0.05)(512) * 16.0),
    }

def reference(A_q, A_k, A_v, A_shift_k, A_ssm_k, A_ssm_D, B_x, B_w1, B_w2, gate_w):
    def _A_ref(q, k, v, shift_k, ssm_k, ssm_D):
        B, S, D = q.shape
        ks = shift_k.shape[-1]
        k_pad = _pad(k, ((0, 0), (ks - 1, 0), (0, 0)))
        k_shift = torch.zeros_like(k)
        for t in range(ks):
            k_shift = k_shift + k_pad[:, t:t + S, :] * shift_k[:, ks - 1 - t][None, None, :]
        kv = k_shift * v
        L = 2 * S
        kv_pad = _pad(kv, ((0, 0), (0, S), (0, 0)))
        kf_pad = _pad(ssm_k, ((0, 0), (0, S)))
        kv_f = (lambda x, axes=(-2,-1): torch.fft.rfft2(x.float(), dim=axes))(kv_pad[:, None, :, :], axes=(1, 2))
        kf_f = (lambda x, axes=(-2,-1): torch.fft.rfft2(x.float(), dim=axes))(kf_pad[:, None, :], axes=(1, 2))
        kf_f = (lambda x, *d: x.permute(*d))(kf_f, 1, 2, 0)
        y_f = kv_f * kf_f[None, :, :, :]
        y = (lambda x, s, axes=(-2,-1): torch.fft.irfft2(x, s=s, dim=axes).to(torch.bfloat16))(y_f, (1, L), axes=(1, 2))[:, 0, :S, :]
        y = y + kv * ssm_D[None, None, :]
        return q * y

    def _B_ref(x, w1, w2):
        h = torch.einsum("bsd,df->bsf", x, w1)
        h = _silu(h)
        out = torch.einsum("bsf,fd->bsd", h, w2)
        return out

    x = A_q
    g = _sigmoid((x * gate_w).sum(-1, keepdims=True))
    a = _A_ref(x, A_k, A_v, A_shift_k, A_ssm_k, A_ssm_D)
    b = _B_ref(x, B_w1, B_w2)
    return g * a + (1 - g) * b
```

```asm
; @launch grid=(256,1,1) block=(512,1,1) lds=163840
.amdgcn_target "amdgcn-amd-amdhsa--gfx950"
.text
.globl gated_mix__ssm_conv_h3__dense_activation_silu__prompt_kernel
.p2align 8
.type gated_mix__ssm_conv_h3__dense_activation_silu__prompt_kernel,@function
gated_mix__ssm_conv_h3__dense_activation_silu__prompt_kernel:
  s_cmp_ge_u32 s2, 256
  s_cbranch_scc1 L_exit
  s_load_dwordx16 s[16:31], s[0:1], 0
  s_load_dwordx8 s[32:39], s[0:1], 64
  s_load_dwordx2 s[40:41], s[0:1], 96
  s_getpc_b64 s[4:5]
L_pc:
  s_lshr_b32 s6, s2, 3
  v_lshrrev_b32 v1, 5, v0
  s_lshl_b32 s6, s6, 11
  s_mov_b32 exec_lo, 1
  v_lshl_add_u32 v1, v1, 7, s6
  s_mov_b32 exec_hi, 1
  v_min_u32 v1, L_exit-L_pc, v1
  global_load_dword v125, v1, s[4:5]
  s_mov_b64 exec, -1
  v_and_b32 v4, 63, v0
  v_lshrrev_b32 v1, 6, v0
  v_mov_b32 v3, 0
  v_lshlrev_b32 v2, 2, v4
  v_readfirstlane_b32 s3, v1
  v_add_u32 v2, 163584, v2
  s_and_b32 s7, s2, 7
  s_lshr_b32 s8, s2, 3
  ds_write_b32 v2, v3
  s_lshr_b32 s13, s7, 1
  s_lshr_b32 s12, s8, 3
  s_lshl2_add_u32 s9, s13, s12
  s_and_b32 s10, s7, 1
  s_and_b32 s11, s8, 7
  s_and_b32 s6, s3, 3
  v_lshlrev_b32 v5, 4, v4
  v_lshlrev_b32 v6, 3, v4
  v_lshrrev_b32 v1, 3, v4
  v_and_b32 v2, 7, v4
  v_mov_b32 v26, 1
  s_and_b32 s42, s6, 1
  s_lshr_b32 s43, s6, 1
  s_lshl1_add_u32 s69, s9, s10
  s_cmp_lt_u32 s3, 4
  s_cbranch_scc0 L_H
L_M:
  s_setprio 1
  v_lshrrev_b32 v32, 4, v4
  v_xor_b32 v33, v2, v32
  v_lshlrev_b32 v33, 4, v33
  v_lshl_add_u32 v11, v1, 10, v33
  v_xor_b32 v12, 64, v11
  v_add_u32 v12, 7168, v12
  v_and_b32 v32, 1, v32
  v_lshlrev_b32 v32, 2, v32
  v_xor_b32 v2, v2, v32
  v_mul_u32_u24 v32, 3584, v1
  v_lshl_add_u32 v7, v2, 4, v32
  v_add_u32 v8, 27648, v7
  v_add_u32 v9, 55296, v7
  v_add_u32 v10, 82944, v7
  s_xor_b32 s13, s69, 1
  s_lshl2_add_u32 s13, s13, s6
  s_lshl_b32 s85, s13, 14
  s_xor_b32 s5, s85, 0x10000
  s_mul_i32 s13, s42, 114688
  s_mul_i32 s14, s10, 1792
  s_add_u32 s13, s13, s14
  s_lshl1_add_u32 s14, s11, s43
  s_lshl_b32 s14, s14, 7
  s_add_u32 s86, s13, s14
  s_lshl_b32 s88, s6, 12
  s_lshl_b32 s89, s6, 11
  v_and_b32 v36, 15, v4
  v_lshrrev_b32 v37, 4, v4
  v_min_u32 v38, 13, v36
  v_lshlrev_b32 v36, 10, v36
  v_lshl_add_u32 v36, v37, 7, v36
  v_mul_u32_u24 v37, 229376, v37
  v_lshl_add_u32 v37, v38, 7, v37
  s_lshl2_add_u32 s13, s9, s6
  s_lshl1_add_u32 s13, s13, s10
  s_mul_i32 s13, s13, 1792
  v_lshlrev_b32 v38, 7, v4
  s_lshl2_add_u32 s15, s9, s6
  s_lshl_b32 s14, s10, 6
  s_add_u32 s15, s15, s14
  s_mul_i32 s15, s15, 14336
  s_mov_b32 s50, 2097152
  s_mov_b32 s51, 0x00020000
  s_mov_b32 s54, 1835008
  s_mov_b32 s55, 0x00020000
  s_cmp_eq_u32 s11, 7
  s_waitcnt lgkmcnt(0)
  s_mov_b32 s52, s30
  s_mov_b32 s53, s31
  s_mov_b32 s48, s16
  s_mov_b32 s49, s17
  s_cbranch_scc1 L_noissue
  s_add_u32 m0, s88, 0
  s_add_u32 s4, s86, 0
  buffer_load_dwordx4 v7, s[52:55], s4 offen offset:0 lds
  buffer_load_dwordx4 v8, s[52:55], s4 offen offset:1024 lds
  buffer_load_dwordx4 v9, s[52:55], s4 offen offset:2048 lds
  buffer_load_dwordx4 v10, s[52:55], s4 offen offset:3072 lds
  s_add_u32 m0, s89, 65536
  s_add_u32 s4, s85, 0
  buffer_load_dwordx4 v11, s[48:51], s4 offen offset:0 lds
  buffer_load_dwordx4 v12, s[48:51], s4 offen offset:1024 lds
  s_barrier
  s_branch L_fpdone
L_noissue:
  s_mov_b32 exec_lo, 65535
  s_mov_b32 exec_hi, 0
  s_add_u32 s14, s13, 458752
  buffer_load_dword v39, v37, s[52:55], s14 offen
  s_mov_b32 exec_lo, 65535
  s_mov_b32 exec_hi, 0
  buffer_load_dword v40, v36, s[48:51], s85 offen offset:256
  s_mov_b32 exec_lo, 65535
  s_mov_b32 exec_hi, 0
  s_add_u32 s14, s13, 688128
  buffer_load_dword v39, v37, s[52:55], s14 offen
  s_mov_b32 exec_lo, 65535
  s_mov_b32 exec_hi, 0
  buffer_load_dword v40, v36, s[48:51], s85 offen offset:384
  s_barrier
  s_branch L_free2
L_H:
  s_setprio 3
  s_memrealtime s[64:65]
  v_lshlrev_b32 v7, 4, v2
  v_lshl_add_u32 v7, v1, 10, v7
  s_lshl_b32 s13, s8, 16
  s_lshl_b32 s14, s7, 7
  s_add_u32 s13, s13, s14
  v_add_u32 v8, s13, v7
  v_subrev_u32 v8, 0x2000, v8
  s_lshl_b32 s14, s6, 14
  s_add_u32 s13, s13, s14
  s_add_u32 s14, s13, 0x2000
  s_mul_i32 s15, s6, 2112
  s_lshl_b32 s68, s7, 9
  s_lshl_b32 s66, s6, 7
  s_add_u32 s68, s68, s66
  v_lshl_add_u32 v9, v1, 4, s68
  s_cmp_eq_u32 s6, 0
  s_cselect_b32 s66, -1, 0
  s_cselect_b32 s67, 0xffffff00, 0
  v_add_u32 v10, 146144, v6
  s_mov_b32 exec_lo, s66
  s_mov_b32 exec_hi, s66
  ds_write2_b32 v10, v3, v3 offset0:0 offset1:1
  s_mov_b64 exec, -1
  s_lshl_b32 s44, s7, 6
  s_lshl1_add_u32 s44, s8, s44
  s_add_u32 s44, s44, s43
  s_lshl_b32 s47, s44, 12
  s_mul_i32 s46, s6, 6400
  s_add_u32 s46, s46, 114688
  v_add_u32 v11, s46, v4
  ds_write_b8 v11, v3
  s_lshl_b32 s44, s42, 8
  s_add_u32 s44, s44, s47
  v_add_u32 v10, 0, v4
  v_mul_u32_u24 v11, 3277, v10
  v_lshrrev_b32 v11, 16, v11
  v_mul_u32_u24 v11, 192, v11
  v_lshl_add_u32 v11, v10, 4, v11
  v_add_u32 v120, s44, v11
  v_subrev_u32 v120, 64, v120
  v_add_u32 v10, 64, v4
  v_mul_u32_u24 v11, 3277, v10
  v_lshrrev_b32 v11, 16, v11
  v_mul_u32_u24 v11, 192, v11
  v_lshl_add_u32 v11, v10, 4, v11
  v_add_u32 v121, s44, v11
  v_subrev_u32 v121, 1088, v121
  v_add_u32 v10, 128, v4
  v_mul_u32_u24 v11, 3277, v10
  v_lshrrev_b32 v11, 16, v11
  v_mul_u32_u24 v11, 192, v11
  v_lshl_add_u32 v11, v10, 4, v11
  v_add_u32 v122, s44, v11
  v_subrev_u32 v122, 2112, v122
  v_cmp_gt_u32 vcc, s47, v120
  v_mov_b32 v10, 0x80000000
  s_mov_b32 s54, 2097152
  s_mov_b32 s55, 0x00020000
  s_mov_b32 s58, 2097152
  s_mov_b32 s59, 0x00020000
  s_mov_b32 s62, 2097152
  s_mov_b32 s63, 0x00020000
  v_cndmask_b32 v120, v120, v10, vcc
  s_or_b32 s45, s2, s6
  s_cmp_lg_u32 s45, 0
  s_waitcnt lgkmcnt(0)
  s_cbranch_scc1 L_nonce_87
  s_or_b32 s64, s64, 1
  v_mov_b32 v30, s64
  v_mov_b32 v31, s64
  s_mov_b64 exec, 1
  global_store_dwordx2 v3, v[30:31], s[38:39] sc1
  s_mov_b64 exec, -1
L_nonce_87:
  s_mov_b32 s60, s24
  s_mov_b32 s61, s25
  s_mov_b32 s52, s18
  s_mov_b32 s53, s19
  s_mov_b32 s56, s20
  s_mov_b32 s57, s21
  s_mov_b32 m0, s46
  s_nop 0
  buffer_load_dwordx4 v120, s[60:63], 0 offen offset:0 nt lds
  buffer_load_dwordx4 v121, s[60:63], 0 offen offset:1024 nt lds
  s_mov_b32 exec_hi, 0
  buffer_load_dwordx4 v122, s[60:63], 0 offen offset:2048 nt lds
  s_mov_b32 exec_hi, -1
  s_add_u32 m0, s15, 146688
  s_nop 0
  buffer_load_dwordx4 v7, s[52:55], s13 offen nt lds
  s_add_u32 m0, s15, 147744
  s_nop 0
  buffer_load_dwordx4 v7, s[52:55], s14 offen nt lds
  s_add_u32 m0, s15, 155136
  s_nop 0
  buffer_load_dwordx4 v7, s[56:59], s13 offen nt lds
  s_add_u32 m0, s15, 156192
  s_nop 0
  buffer_load_dwordx4 v7, s[56:59], s14 offen nt lds
  s_mov_b32 m0, 145632
  s_mov_b32 exec_lo, 0
  s_mov_b32 exec_hi, s67
  buffer_load_dwordx4 v8, s[52:55], 0 offen lds
  s_mov_b64 exec, -1
  global_load_dwordx4 v[64:67], v9, s[22:23]
  s_barrier
  s_mov_b32 s32, 0xffff0000
  s_mov_b32 s33, 0xbfb8aa3b
  s_mov_b32 s48, s16
  s_mov_b32 s49, s17
  s_mov_b32 s50, 2097152
  s_mov_b32 s51, 0x00020000
  s_add_u32 s72, s40, 234881024
  s_addc_u32 s73, s41, 0
  s_mov_b32 s74, 33554432
  s_mov_b32 s75, 0x00020000
  s_lshl_b32 s13, s69, 6
  s_lshl3_add_u32 s13, s11, s13
  s_lshl1_add_u32 s45, s6, s13
  v_and_b32 v123, 31, v4
  v_lshlrev_b32 v123, 4, v123
  v_lshrrev_b32 v124, 5, v4
  v_add_u32 v124, s45, v124
  v_lshl_add_u32 v124, v124, 10, v123
  v_and_b32 v8, 3, v4
  v_lshlrev_b32 v8, 2, v8
  v_add_u32 v24, 163600, v8
  s_lshl_b32 s13, s6, 2
  s_add_u32 s13, s13, 163600
  v_mov_b32 v25, s13
  v_mov_b32 v13, 163584
  v_mul_u32_u24 v8, 1056, v2
  v_lshl_add_u32 v8, v1, 2, v8
  s_lshl_b32 s13, s6, 5
  s_add_u32 s13, s13, 145632
  v_add_u32 v8, s13, v8
  v_sub_u32 v9, 7, v2
  v_lshlrev_b32 v9, 4, v9
  v_lshl_add_u32 v9, v1, 14, v9
  v_and_b32 v1, 15, v4
  v_lshrrev_b32 v2, 4, v4
  v_lshl_add_u32 v14, v2, 3, v1
  v_add_u32 v14, 17, v14
  v_and_b32 v15, 1, v14
  v_mul_u32_u24 v15, 3134, v15
  v_lshl_add_u32 v14, v14, 1, v15
  v_add_u32 v14, s46, v14
  v_add_u32 v15, 960, v14
  v_add_u32 v16, 1920, v14
  v_add_u32 v17, s46, v5
  v_lshlrev_b32 v11, 1, v1
  v_sub_u32 v11, v2, v11
  s_mul_i32 s13, s43, 4608
  s_lshl_b32 s14, s42, 8
  s_add_u32 s13, s13, s14
  s_add_u32 s13, s13, 115168
  v_lshl_add_u32 v12, v11, 4, s13
  global_load_dwordx2 v[30:31], v3, s[38:39] sc1
  s_waitcnt vmcnt(7)
  ds_read_b128 v[32:35], v17 offset:0
  ds_read_b32 v36, v17 offset:16
  ds_read_b128 v[40:43], v17 offset:1024
  ds_read_b32 v44, v17 offset:1040
  ds_read_b128 v[48:51], v17 offset:2048
  ds_read_b32 v52, v17 offset:2064
  s_waitcnt lgkmcnt(4)
  v_alignbit_b32 v32, v33, v32, 16
  v_alignbit_b32 v33, v34, v33, 16
  v_alignbit_b32 v34, v35, v34, 16
  v_alignbit_b32 v35, v36, v35, 16
  ds_write_b128 v17, v[32:35] offset:3136
  s_waitcnt lgkmcnt(3)
  v_alignbit_b32 v40, v41, v40, 16
  v_alignbit_b32 v41, v42, v41, 16
  v_alignbit_b32 v42, v43, v42, 16
  v_alignbit_b32 v43, v44, v43, 16
  ds_write_b128 v17, v[40:43] offset:4160
  s_waitcnt lgkmcnt(2)
  v_alignbit_b32 v48, v49, v48, 16
  v_alignbit_b32 v49, v50, v49, 16
  v_alignbit_b32 v50, v51, v50, 16
  v_alignbit_b32 v51, v52, v51, 16
  ds_write_b128 v17, v[48:51] offset:5184
  s_setprio 0
  ds_read2_b32 a[0:1], v14 offset0:0 offset1:1
  ds_read2_b32 a[2:3], v14 offset0:2 offset1:3
  ds_read2_b32 a[32:33], v14 offset0:16 offset1:17
  ds_read2_b32 a[34:35], v14 offset0:18 offset1:19
  ds_read2_b32 a[64:65], v14 offset0:32 offset1:33
  ds_read2_b32 a[66:67], v14 offset0:34 offset1:35
  ds_read2_b32 a[96:97], v14 offset0:48 offset1:49
  ds_read2_b32 a[98:99], v14 offset0:50 offset1:51
  ds_read2_b32 a[4:5], v14 offset0:80 offset1:81
  ds_read2_b32 a[6:7], v14 offset0:82 offset1:83
  ds_read2_b32 a[36:37], v14 offset0:96 offset1:97
  ds_read2_b32 a[38:39], v14 offset0:98 offset1:99
  ds_read2_b32 a[68:69], v14 offset0:112 offset1:113
  ds_read2_b32 a[70:71], v14 offset0:114 offset1:115
  ds_read2_b32 a[100:101], v14 offset0:128 offset1:129
  ds_read2_b32 a[102:103], v14 offset0:130 offset1:131
  ds_read2_b32 a[8:9], v14 offset0:160 offset1:161
  ds_read2_b32 a[10:11], v14 offset0:162 offset1:163
  ds_read2_b32 a[40:41], v14 offset0:176 offset1:177
  ds_read2_b32 a[42:43], v14 offset0:178 offset1:179
  ds_read2_b32 a[72:73], v14 offset0:192 offset1:193
  ds_read2_b32 a[74:75], v14 offset0:194 offset1:195
  ds_read2_b32 a[104:105], v14 offset0:208 offset1:209
  ds_read2_b32 a[106:107], v14 offset0:210 offset1:211
  ds_read2_b32 a[12:13], v15 offset0:0 offset1:1
  ds_read2_b32 a[14:15], v15 offset0:2 offset1:3
  ds_read2_b32 a[44:45], v15 offset0:16 offset1:17
  ds_read2_b32 a[46:47], v15 offset0:18 offset1:19
  ds_read2_b32 a[76:77], v15 offset0:32 offset1:33
  ds_read2_b32 a[78:79], v15 offset0:34 offset1:35
  ds_read2_b32 a[108:109], v15 offset0:48 offset1:49
  ds_read2_b32 a[110:111], v15 offset0:50 offset1:51
  ds_read2_b32 a[16:17], v15 offset0:80 offset1:81
  ds_read2_b32 a[18:19], v15 offset0:82 offset1:83
  ds_read2_b32 a[48:49], v15 offset0:96 offset1:97
  ds_read2_b32 a[50:51], v15 offset0:98 offset1:99
  ds_read2_b32 a[80:81], v15 offset0:112 offset1:113
  ds_read2_b32 a[82:83], v15 offset0:114 offset1:115
  ds_read2_b32 a[112:113], v15 offset0:128 offset1:129
  ds_read2_b32 a[114:115], v15 offset0:130 offset1:131
  ds_read2_b32 a[20:21], v15 offset0:160 offset1:161
  ds_read2_b32 a[22:23], v15 offset0:162 offset1:163
  ds_read2_b32 a[52:53], v15 offset0:176 offset1:177
  ds_read2_b32 a[54:55], v15 offset0:178 offset1:179
  ds_read2_b32 a[84:85], v15 offset0:192 offset1:193
  ds_read2_b32 a[86:87], v15 offset0:194 offset1:195
  ds_read2_b32 a[116:117], v15 offset0:208 offset1:209
  ds_read2_b32 a[118:119], v15 offset0:210 offset1:211
  s_setprio 3
  s_lshl2_add_u32 s13, s7, s6
  s_lshl_b32 s13, s13, 11
  s_lshl3_add_u32 s13, s8, s13
  s_add_u32 s77, s13, 28311552
  s_lshl_b32 s14, s7, 5
  s_add_u32 s14, s14, s8
  s_lshl2_add_u32 s14, s14, s6
  s_lshl_b32 s14, s14, 6
  s_add_u32 s76, s14, 28311552
  v_lshlrev_b32 v11, 8, v4
  s_waitcnt vmcnt(1)
  ds_write_b32 v25, v26
  v_add_u32 v26, 1, v26
  v_lshlrev_b32 v108, 16, v64
  v_lshlrev_b32 v109, 16, v66
  v_and_b32 v110, s32, v64
  v_and_b32 v111, s32, v66
  v_lshlrev_b32 v112, 16, v65
  v_lshlrev_b32 v113, 16, v67
  v_and_b32 v114, s32, v65
  v_and_b32 v115, s32, v67
  s_waitcnt lgkmcnt(0)
  ds_read_b32 v28, v24 offset:0
  s_waitcnt lgkmcnt(0)
  v_cmp_gt_u32 vcc, 1, v28
  s_cbranch_vccnz L_sp_89
L_sd_90:
  ds_read_b32 v32, v8 offset:640
  ds_read_b32 v33, v8 offset:768
  ds_read_b32 v34, v8 offset:896
  ds_read_b32 v35, v8 offset:1056
  ds_read_b32 v36, v8 offset:1184
  ds_read_b32 v37, v8 offset:1312
  ds_read_b32 v38, v8 offset:1440
  ds_read_b32 v39, v8 offset:1568
  ds_read_b32 v40, v8 offset:1696
  ds_read_b32 v41, v8 offset:1824
  ds_read_b32 v42, v8 offset:1952
  ds_read_b32 v44, v8 offset:9504
  ds_read_b32 v45, v8 offset:9632
  ds_read_b32 v46, v8 offset:9760
  ds_read_b32 v47, v8 offset:9888
  ds_read_b32 v48, v8 offset:10016
  ds_read_b32 v49, v8 offset:10144
  ds_read_b32 v50, v8 offset:10272
  ds_read_b32 v51, v8 offset:10400
  s_waitcnt lgkmcnt(15)
  v_lshlrev_b32 v84, 16, v32
  v_and_b32 v85, s32, v32
  v_lshlrev_b32 v86, 16, v33
  v_and_b32 v87, s32, v33
  v_lshlrev_b32 v88, 16, v34
  v_and_b32 v89, s32, v34
  v_lshlrev_b32 v90, 16, v35
  v_and_b32 v91, s32, v35
  s_waitcnt lgkmcnt(14)
  v_lshlrev_b32 v92, 16, v36
  v_and_b32 v93, s32, v36
  s_waitcnt lgkmcnt(13)
  v_lshlrev_b32 v94, 16, v37
  v_and_b32 v95, s32, v37
  s_waitcnt lgkmcnt(12)
  v_lshlrev_b32 v96, 16, v38
  v_and_b32 v97, s32, v38
  s_waitcnt lgkmcnt(11)
  v_lshlrev_b32 v98, 16, v39
  v_and_b32 v99, s32, v39
  s_waitcnt lgkmcnt(10)
  v_lshlrev_b32 v100, 16, v40
  v_and_b32 v101, s32, v40
  s_waitcnt lgkmcnt(9)
  v_lshlrev_b32 v102, 16, v41
  v_and_b32 v103, s32, v41
  s_waitcnt lgkmcnt(8)
  v_lshlrev_b32 v104, 16, v42
  v_and_b32 v105, s32, v42
  s_waitcnt lgkmcnt(0)
  v_mul_f32 v116, v84, v114
  v_mul_f32 v117, v85, v115
  v_mul_f32 v52, v86, v112
  v_mul_f32 v53, v87, v113
  v_cvt_pk_bf16_f32 v116, 0, v116
  v_cvt_pk_bf16_f32 v117, 0, v117
  v_cvt_pk_bf16_f32 v52, 0, v52
  v_cvt_pk_bf16_f32 v53, 0, v53
  v_add_f32 v116, v116, v52
  v_add_f32 v117, v117, v53
  v_mul_f32 v52, v88, v110
  v_mul_f32 v53, v89, v111
  v_cvt_pk_bf16_f32 v116, 0, v116
  v_cvt_pk_bf16_f32 v117, 0, v117
  v_cvt_pk_bf16_f32 v52, 0, v52
  v_cvt_pk_bf16_f32 v53, 0, v53
  v_add_f32 v116, v116, v52
  v_add_f32 v117, v117, v53
  v_mul_f32 v52, v90, v108
  v_mul_f32 v53, v91, v109
  v_cvt_pk_bf16_f32 v116, 0, v116
  v_cvt_pk_bf16_f32 v117, 0, v117
  v_cvt_pk_bf16_f32 v52, 0, v52
  v_cvt_pk_bf16_f32 v53, 0, v53
  v_add_f32 v116, v116, v52
  v_add_f32 v117, v117, v53
  v_lshlrev_b32 v52, 16, v44
  v_and_b32 v53, s32, v44
  v_cvt_pk_bf16_f32 v116, 0, v116
  v_cvt_pk_bf16_f32 v117, 0, v117
  v_mul_f32 v32, v116, v52
  v_mul_f32 v33, v117, v53
  v_mul_f32 v116, v86, v114
  v_mul_f32 v117, v87, v115
  v_mul_f32 v52, v88, v112
  v_mul_f32 v53, v89, v113
  v_cvt_pk_bf16_f32 v116, 0, v116
  v_cvt_pk_bf16_f32 v117, 0, v117
  v_cvt_pk_bf16_f32 v52, 0, v52
  v_cvt_pk_bf16_f32 v53, 0, v53
  v_add_f32 v116, v116, v52
  v_add_f32 v117, v117, v53
  v_mul_f32 v52, v90, v110
  v_mul_f32 v53, v91, v111
  v_cvt_pk_bf16_f32 v116, 0, v116
  v_cvt_pk_bf16_f32 v117, 0, v117
  v_cvt_pk_bf16_f32 v52, 0, v52
  v_cvt_pk_bf16_f32 v53, 0, v53
  v_add_f32 v116, v116, v52
  v_add_f32 v117, v117, v53
  v_mul_f32 v52, v92, v108
  v_mul_f32 v53, v93, v109
  v_cvt_pk_bf16_f32 v116, 0, v116
  v_cvt_pk_bf16_f32 v117, 0, v117
  v_cvt_pk_bf16_f32 v52, 0, v52
  v_cvt_pk_bf16_f32 v53, 0, v53
  v_add_f32 v116, v116, v52
  v_add_f32 v117, v117, v53
  v_lshlrev_b32 v52, 16, v45
  v_and_b32 v53, s32, v45
  v_cvt_pk_bf16_f32 v116, 0, v116
  v_cvt_pk_bf16_f32 v117, 0, v117
  v_mul_f32 v34, v116, v52
  v_mul_f32 v35, v117, v53
  v_mul_f32 v116, v88, v114
  v_mul_f32 v117, v89, v115
  v_mul_f32 v52, v90, v112
  v_mul_f32 v53, v91, v113
  v_cvt_pk_bf16_f32 v116, 0, v116
  v_cvt_pk_bf16_f32 v117, 0, v117
  v_cvt_pk_bf16_f32 v52, 0, v52
  v_cvt_pk_bf16_f32 v53, 0, v53
  v_add_f32 v116, v116, v52
  v_add_f32 v117, v117, v53
  v_mul_f32 v52, v92, v110
  v_mul_f32 v53, v93, v111
  v_cvt_pk_bf16_f32 v116, 0, v116
  v_cvt_pk_bf16_f32 v117, 0, v117
  v_cvt_pk_bf16_f32 v52, 0, v52
  v_cvt_pk_bf16_f32 v53, 0, v53
  v_add_f32 v116, v116, v52
  v_add_f32 v117, v117, v53
  v_mul_f32 v52, v94, v108
  v_mul_f32 v53, v95, v109
  v_cvt_pk_bf16_f32 v116, 0, v116
  v_cvt_pk_bf16_f32 v117, 0, v117
  v_cvt_pk_bf16_f32 v52, 0, v52
  v_cvt_pk_bf16_f32 v53, 0, v53
  v_add_f32 v116, v116, v52
  v_add_f32 v117, v117, v53
  v_lshlrev_b32 v52, 16, v46
  v_and_b32 v53, s32, v46
  v_cvt_pk_bf16_f32 v116, 0, v116
  v_cvt_pk_bf16_f32 v117, 0, v117
  v_mul_f32 v36, v116, v52
  v_mul_f32 v37, v117, v53
  v_mul_f32 v116, v90, v114
  v_mul_f32 v117, v91, v115
  v_mul_f32 v52, v92, v112
  v_mul_f32 v53, v93, v113
  v_cvt_pk_bf16_f32 v116, 0, v116
  v_cvt_pk_bf16_f32 v117, 0, v117
  v_cvt_pk_bf16_f32 v52, 0, v52
  v_cvt_pk_bf16_f32 v53, 0, v53
  v_add_f32 v116, v116, v52
  v_add_f32 v117, v117, v53
  v_mul_f32 v52, v94, v110
  v_mul_f32 v53, v95, v111
  v_cvt_pk_bf16_f32 v116, 0, v116
  v_cvt_pk_bf16_f32 v117, 0, v117
  v_cvt_pk_bf16_f32 v52, 0, v52
  v_cvt_pk_bf16_f32 v53, 0, v53
  v_add_f32 v116, v116, v52
  v_add_f32 v117, v117, v53
  v_mul_f32 v52, v96, v108
  v_mul_f32 v53, v97, v109
  v_cvt_pk_bf16_f32 v116, 0, v116
  v_cvt_pk_bf16_f32 v117, 0, v117
  v_cvt_pk_bf16_f32 v52, 0, v52
  v_cvt_pk_bf16_f32 v53, 0, v53
  v_add_f32 v116, v116, v52
  v_add_f32 v117, v117, v53
  v_lshlrev_b32 v52, 16, v47
  v_and_b32 v53, s32, v47
  v_cvt_pk_bf16_f32 v116, 0, v116
  v_cvt_pk_bf16_f32 v117, 0, v117
  v_mul_f32 v38, v116, v52
  v_mul_f32 v39, v117, v53
  v_mul_f32 v116, v92, v114
  v_mul_f32 v117, v93, v115
  v_mul_f32 v52, v94, v112
  v_mul_f32 v53, v95, v113
  v_cvt_pk_bf16_f32 v116, 0, v116
  v_cvt_pk_bf16_f32 v117, 0, v117
  v_cvt_pk_bf16_f32 v52, 0, v52
  v_cvt_pk_bf16_f32 v53, 0, v53
  v_add_f32 v116, v116, v52
  v_add_f32 v117, v117, v53
  v_mul_f32 v52, v96, v110
  v_mul_f32 v53, v97, v111
  v_cvt_pk_bf16_f32 v116, 0, v116
  v_cvt_pk_bf16_f32 v117, 0, v117
  v_cvt_pk_bf16_f32 v52, 0, v52
  v_cvt_pk_bf16_f32 v53, 0, v53
  v_add_f32 v116, v116, v52
  v_add_f32 v117, v117, v53
  v_mul_f32 v52, v98, v108
  v_mul_f32 v53, v99, v109
  v_cvt_pk_bf16_f32 v116, 0, v116
  v_cvt_pk_bf16_f32 v117, 0, v117
  v_cvt_pk_bf16_f32 v52, 0, v52
  v_cvt_pk_bf16_f32 v53, 0, v53
  v_add_f32 v116, v116, v52
  v_add_f32 v117, v117, v53
  v_lshlrev_b32 v52, 16, v48
  v_and_b32 v53, s32, v48
  v_cvt_pk_bf16_f32 v116, 0, v116
  v_cvt_pk_bf16_f32 v117, 0, v117
  v_mul_f32 v40, v116, v52
  v_mul_f32 v41, v117, v53
  v_mul_f32 v116, v94, v114
  v_mul_f32 v117, v95, v115
  v_mul_f32 v52, v96, v112
  v_mul_f32 v53, v97, v113
  v_cvt_pk_bf16_f32 v116, 0, v116
  v_cvt_pk_bf16_f32 v117, 0, v117
  v_cvt_pk_bf16_f32 v52, 0, v52
  v_cvt_pk_bf16_f32 v53, 0, v53
  v_add_f32 v116, v116, v52
  v_add_f32 v117, v117, v53
  v_mul_f32 v52, v98, v110
  v_mul_f32 v53, v99, v111
  v_cvt_pk_bf16_f32 v116, 0, v116
  v_cvt_pk_bf16_f32 v117, 0, v117
  v_cvt_pk_bf16_f32 v52, 0, v52
  v_cvt_pk_bf16_f32 v53, 0, v53
  v_add_f32 v116, v116, v52
  v_add_f32 v117, v117, v53
  v_mul_f32 v52, v100, v108
  v_mul_f32 v53, v101, v109
  v_cvt_pk_bf16_f32 v116, 0, v116
  v_cvt_pk_bf16_f32 v117, 0, v117
  v_cvt_pk_bf16_f32 v52, 0, v52
  v_cvt_pk_bf16_f32 v53, 0, v53
  v_add_f32 v116, v116, v52
  v_add_f32 v117, v117, v53
  v_lshlrev_b32 v52, 16, v49
  v_and_b32 v53, s32, v49
  v_cvt_pk_bf16_f32 v116, 0, v116
  v_cvt_pk_bf16_f32 v117, 0, v117
  v_mul_f32 v54, v116, v52
  v_mul_f32 v55, v117, v53
  v_mul_f32 v116, v96, v114
  v_mul_f32 v117, v97, v115
  v_mul_f32 v52, v98, v112
  v_mul_f32 v53, v99, v113
  v_cvt_pk_bf16_f32 v116, 0, v116
  v_cvt_pk_bf16_f32 v117, 0, v117
  v_cvt_pk_bf16_f32 v52, 0, v52
  v_cvt_pk_bf16_f32 v53, 0, v53
  v_add_f32 v116, v116, v52
  v_add_f32 v117, v117, v53
  v_mul_f32 v52, v100, v110
  v_mul_f32 v53, v101, v111
  v_cvt_pk_bf16_f32 v116, 0, v116
  v_cvt_pk_bf16_f32 v117, 0, v117
  v_cvt_pk_bf16_f32 v52, 0, v52
  v_cvt_pk_bf16_f32 v53, 0, v53
  v_add_f32 v116, v116, v52
  v_add_f32 v117, v117, v53
  v_mul_f32 v52, v102, v108
  v_mul_f32 v53, v103, v109
  v_cvt_pk_bf16_f32 v116, 0, v116
  v_cvt_pk_bf16_f32 v117, 0, v117
  v_cvt_pk_bf16_f32 v52, 0, v52
  v_cvt_pk_bf16_f32 v53, 0, v53
  v_add_f32 v116, v116, v52
  v_add_f32 v117, v117, v53
  v_lshlrev_b32 v52, 16, v50
  v_and_b32 v53, s32, v50
  v_cvt_pk_bf16_f32 v116, 0, v116
  v_cvt_pk_bf16_f32 v117, 0, v117
  v_mul_f32 v56, v116, v52
  v_mul_f32 v57, v117, v53
  v_mul_f32 v116, v98, v114
  v_mul_f32 v117, v99, v115
  v_mul_f32 v52, v100, v112
  v_mul_f32 v53, v101, v113
  v_cvt_pk_bf16_f32 v116, 0, v116
  v_cvt_pk_bf16_f32 v117, 0, v117
  v_cvt_pk_bf16_f32 v52, 0, v52
  v_cvt_pk_bf16_f32 v53, 0, v53
  v_add_f32 v116, v116, v52
  v_add_f32 v117, v117, v53
  v_mul_f32 v52, v102, v110
  v_mul_f32 v53, v103, v111
  v_cvt_pk_bf16_f32 v116, 0, v116
  v_cvt_pk_bf16_f32 v117, 0, v117
  v_cvt_pk_bf16_f32 v52, 0, v52
  v_cvt_pk_bf16_f32 v53, 0, v53
  v_add_f32 v116, v116, v52
  v_add_f32 v117, v117, v53
  v_mul_f32 v52, v104, v108
  v_mul_f32 v53, v105, v109
  v_cvt_pk_bf16_f32 v116, 0, v116
  v_cvt_pk_bf16_f32 v117, 0, v117
  v_cvt_pk_bf16_f32 v52, 0, v52
  v_cvt_pk_bf16_f32 v53, 0, v53
  v_add_f32 v116, v116, v52
  v_add_f32 v117, v117, v53
  v_lshlrev_b32 v52, 16, v51
  v_and_b32 v53, s32, v51
  v_cvt_pk_bf16_f32 v116, 0, v116
  v_cvt_pk_bf16_f32 v117, 0, v117
  v_mul_f32 v58, v116, v52
  v_mul_f32 v59, v117, v53
  s_waitcnt vmcnt(0)
  v_cmp_eq_u32 vcc, 0, v30
  s_cbranch_vccnz L_np_92
L_nd_93:
  ds_write_b64 v13, v[30:31] offset:48
  v_readfirstlane_b32 s64, v30
  v_readfirstlane_b32 s65, v31
  s_lshl2_add_u32 s13, s7, s6
  s_lshl_b32 s13, s13, 17
  s_sub_u32 s14, 31, s8
  s_lshl_b32 s14, s14, 7
  s_add_u32 s13, s13, s14
  s_add_u32 s14, s13, 4096
  s_add_u32 s15, s13, 8192
  v_cvt_pk_bf16_f32 v84, v58, v56
  v_cvt_pk_bf16_f32 v85, v54, v40
  v_cvt_pk_bf16_f32 v86, v38, v36
  v_mov_b32 v87, v30
  buffer_store_dwordx4 v[84:87], v9, s[72:75], s13 offen sc1
  v_cvt_pk_bf16_f32 v88, v59, v57
  v_cvt_pk_bf16_f32 v89, v55, v41
  v_cvt_pk_bf16_f32 v90, v39, v37
  v_mov_b32 v91, v30
  buffer_store_dwordx4 v[88:91], v9, s[72:75], s14 offen sc1
  v_cvt_pk_bf16_f32 v92, v34, v32
  v_cvt_pk_bf16_f32 v93, v35, v33
  v_mov_b32 v95, v30
  buffer_store_dwordx4 v[92:95], v9, s[72:75], s15 offen sc1
  s_mov_b64 exec, 0xff
  buffer_store_dwordx2 v[30:31], v11, s[72:75], s77 offen offset:0 sc1
  s_mov_b64 exec, -1
  s_setprio 0
  ds_read2_b32 a[24:25], v16 offset0:0 offset1:1
  ds_read2_b32 a[26:27], v16 offset0:2 offset1:3
  ds_read2_b32 a[56:57], v16 offset0:16 offset1:17
  ds_read2_b32 a[58:59], v16 offset0:18 offset1:19
  ds_read2_b32 a[88:89], v16 offset0:32 offset1:33
  ds_read2_b32 a[90:91], v16 offset0:34 offset1:35
  ds_read2_b32 a[120:121], v16 offset0:48 offset1:49
  ds_read2_b32 a[122:123], v16 offset0:50 offset1:51
  ds_read2_b32 a[28:29], v16 offset0:80 offset1:81
  ds_read2_b32 a[30:31], v16 offset0:82 offset1:83
  ds_read2_b32 a[60:61], v16 offset0:96 offset1:97
  ds_read2_b32 a[62:63], v16 offset0:98 offset1:99
  ds_read2_b32 a[92:93], v16 offset0:112 offset1:113
  ds_read2_b32 a[94:95], v16 offset0:114 offset1:115
  ds_read2_b32 a[124:125], v16 offset0:128 offset1:129
  ds_read2_b32 a[126:127], v16 offset0:130 offset1:131
  s_setprio 3
  s_waitcnt vmcnt(1)
  buffer_load_dwordx4 v[68:71], v124, s[48:51], 0 offen
  buffer_load_dwordx4 v[72:75], v124, s[48:51], 0 offen offset:512
  global_load_dwordx4 v[76:79], v123, s[34:35]
  global_load_dwordx4 v[80:83], v123, s[34:35] offset:512
  v_mov_b32 v26, 3
  ds_write_b32 v25, v26
  v_add_u32 v26, 1, v26
  s_mul_i32 s13, s43, 4608
  s_lshl_b32 s14, s42, 8
  s_add_u32 s13, s13, s14
  s_add_u32 s13, s13, 118784
  v_lshl_add_u32 v8, v4, 2, s13
  s_sub_u32 s14, 3, s6
  s_lshl_b32 s14, s14, 10
  s_andn2_b32 s13, s47, 4096
  s_lshl1_add_u32 s71, s13, s14
  s_add_u32 s98, s71, 4096
  s_add_u32 s99, s71, 8192
  s_add_u32 s14, s14, 114688
  v_add_u32 v9, s14, v5
  ds_read_b32 v28, v24 offset:0
  s_waitcnt lgkmcnt(0)
  v_cmp_gt_u32 vcc, 3, v28
  s_cbranch_vccnz L_sp_96
L_sd_97:
  ds_write_b32 v8, v3
  s_waitcnt lgkmcnt(0)
  s_load_dwordx16 s[80:95], s[72:73], s76 glc
  s_mul_i32 s13, s69, 229376
  s_lshl2_add_u32 s14, s11, s6
  s_lshl_b32 s14, s14, 11
  s_add_u32 s13, s13, s14
  s_add_u32 s78, s13, 4194304
  s_lshl_b32 s13, s69, 15
  s_lshl_b32 s14, s43, 11
  s_add_u32 s13, s13, s14
  s_add_u32 s13, s13, 30408704
  s_lshl_b32 s14, s11, 12
  s_add_u32 s61, s13, s14
  s_lshl1_add_u32 s14, s11, s42
  s_lshl2_add_u32 s79, s14, s13
  v_cmp_gt_u32 vcc, 8, v4
  v_lshlrev_b32 v18, 12, v4
  v_mov_b32 v20, 2.0
  v_cndmask_b32 v21, v20, v18, vcc
  s_lshl_b32 s14, s6, 12
  s_add_u32 s14, s14, 123904
  v_add_u32 v22, s14, v5
  v_subrev_u32 v23, 16, v25
  s_xor_b32 s14, s6, 2
  s_lshl_b32 s14, s14, 12
  s_add_u32 s14, s14, 123904
  v_add_u32 v19, s14, v5
  s_mov_b32 s13, s11
  s_cmp_ge_u32 s13, 7
  s_cselect_b32 s14, 7, 0
  s_sub_u32 s52, s13, s14
  s_add_u32 s13, s52, 1
  s_cmp_ge_u32 s13, 7
  s_cselect_b32 s14, 7, 0
  s_sub_u32 s53, s13, s14
  s_add_u32 s13, s53, 1
  s_cmp_ge_u32 s13, 7
  s_cselect_b32 s14, 7, 0
  s_sub_u32 s54, s13, s14
  s_add_u32 s13, s54, 1
  s_cmp_ge_u32 s13, 7
  s_cselect_b32 s14, 7, 0
  s_sub_u32 s55, s13, s14
  s_add_u32 s13, s55, 1
  s_cmp_ge_u32 s13, 7
  s_cselect_b32 s14, 7, 0
  s_sub_u32 s56, s13, s14
  s_add_u32 s13, s56, 1
  s_cmp_ge_u32 s13, 7
  s_cselect_b32 s14, 7, 0
  s_sub_u32 s57, s13, s14
  s_add_u32 s13, s57, 1
  s_cmp_ge_u32 s13, 7
  s_cselect_b32 s14, 7, 0
  s_sub_u32 s58, s13, s14
  s_mul_i32 s13, s69, 229376
  s_mul_i32 s14, s42, 57344
  s_add_u32 s13, s13, s14
  s_lshl_b32 s14, s43, 12
  s_add_u32 s13, s13, s14
  s_add_u32 s59, s13, 4194304
  s_lshl_b32 s52, s52, 13
  s_add_u32 s52, s52, s59
  s_lshl_b32 s53, s53, 13
  s_add_u32 s53, s53, s59
  s_lshl_b32 s54, s54, 13
  s_add_u32 s54, s54, s59
  s_lshl_b32 s55, s55, 13
  s_add_u32 s55, s55, s59
  s_lshl_b32 s56, s56, 13
  s_add_u32 s56, s56, s59
  s_lshl_b32 s57, s57, 13
  s_add_u32 s57, s57, s59
  s_lshl_b32 s58, s58, 13
  s_add_u32 s58, s58, s59
  s_lshl2_add_u32 s13, s2, s6
  s_xor_b32 s14, s13, 4
  s_lshl_b32 s15, s14, 13
  s_add_u32 s62, s15, 12582912
  s_lshl_b32 s15, s14, 6
  s_add_u32 s63, s15, 28508160
  v_bfe_u32 v1, v4, 2, 2
  v_and_b32 v14, 3, v4
  v_lshlrev_b32 v14, 3, v14
  v_lshl_add_u32 v14, v1, 7, v14
  v_bfe_u32 v1, v4, 3, 1
  v_lshl_add_u32 v14, v1, 6, v14
  v_bfe_u32 v1, v4, 4, 1
  v_lshl_add_u32 v14, v1, 5, v14
  v_lshrrev_b32 v1, 5, v4
  v_lshl_add_u32 v14, v1, 9, v14
  s_lshl_b32 s13, s43, 6
  s_lshl_b32 s14, s43, 13
  v_xor_b32 v14, s13, v14
  v_add_u32 v14, s14, v14
  v_xor_b32 v15, 64, v14
  v_add_u32 v16, 0x10000, v14
  v_add_u32 v17, 0x10000, v15
  s_waitcnt vmcnt(0)
  v_lshlrev_b32 v86, 16, v68
  v_and_b32 v87, s32, v68
  v_lshlrev_b32 v88, 16, v76
  v_and_b32 v89, s32, v76
  v_mul_f32 v84, v86, v88
  v_mul_f32 v85, v87, v89
  v_cvt_pk_bf16_f32 v84, 0, v84
  v_cvt_pk_bf16_f32 v85, 0, v85
  v_lshlrev_b32 v86, 16, v69
  v_and_b32 v87, s32, v69
  v_lshlrev_b32 v88, 16, v77
  v_and_b32 v89, s32, v77
  v_mul_f32 v86, v86, v88
  v_mul_f32 v87, v87, v89
  v_cvt_pk_bf16_f32 v86, 0, v86
  v_cvt_pk_bf16_f32 v87, 0, v87
  v_add_f32 v84, v84, v86
  v_add_f32 v85, v85, v87
  v_lshlrev_b32 v86, 16, v70
  v_and_b32 v87, s32, v70
  v_lshlrev_b32 v88, 16, v78
  v_and_b32 v89, s32, v78
  v_mul_f32 v86, v86, v88
  v_mul_f32 v87, v87, v89
  v_cvt_pk_bf16_f32 v86, 0, v86
  v_cvt_pk_bf16_f32 v87, 0, v87
  v_add_f32 v84, v84, v86
  v_add_f32 v85, v85, v87
  v_lshlrev_b32 v86, 16, v71
  v_and_b32 v87, s32, v71
  v_lshlrev_b32 v88, 16, v79
  v_and_b32 v89, s32, v79
  v_mul_f32 v86, v86, v88
  v_mul_f32 v87, v87, v89
  v_cvt_pk_bf16_f32 v86, 0, v86
  v_cvt_pk_bf16_f32 v87, 0, v87
  v_add_f32 v84, v84, v86
  v_add_f32 v85, v85, v87
  v_lshlrev_b32 v86, 16, v72
  v_and_b32 v87, s32, v72
  v_lshlrev_b32 v88, 16, v80
  v_and_b32 v89, s32, v80
  v_mul_f32 v86, v86, v88
  v_mul_f32 v87, v87, v89
  v_cvt_pk_bf16_f32 v86, 0, v86
  v_cvt_pk_bf16_f32 v87, 0, v87
  v_add_f32 v84, v84, v86
  v_add_f32 v85, v85, v87
  v_lshlrev_b32 v86, 16, v73
  v_and_b32 v87, s32, v73
  v_lshlrev_b32 v88, 16, v81
  v_and_b32 v89, s32, v81
  v_mul_f32 v86, v86, v88
  v_mul_f32 v87, v87, v89
  v_cvt_pk_bf16_f32 v86, 0, v86
  v_cvt_pk_bf16_f32 v87, 0, v87
  v_add_f32 v84, v84, v86
  v_add_f32 v85, v85, v87
  v_lshlrev_b32 v86, 16, v74
  v_and_b32 v87, s32, v74
  v_lshlrev_b32 v88, 16, v82
  v_and_b32 v89, s32, v82
  v_mul_f32 v86, v86, v88
  v_mul_f32 v87, v87, v89
  v_cvt_pk_bf16_f32 v86, 0, v86
  v_cvt_pk_bf16_f32 v87, 0, v87
  v_add_f32 v84, v84, v86
  v_add_f32 v85, v85, v87
  v_lshlrev_b32 v86, 16, v75
  v_and_b32 v87, s32, v75
  v_lshlrev_b32 v88, 16, v83
  v_and_b32 v89, s32, v83
  v_mul_f32 v86, v86, v88
  v_mul_f32 v87, v87, v89
  v_cvt_pk_bf16_f32 v86, 0, v86
  v_cvt_pk_bf16_f32 v87, 0, v87
  v_add_f32 v84, v84, v86
  v_add_f32 v85, v85, v87
  v_add_f32 v84, v84, v85
  s_nop 1
  v_add_f32_dpp v84, v84, v84 row_shr:1 row_mask:0xf bank_mask:0xf bound_ctrl:0
  s_nop 1
  v_add_f32_dpp v84, v84, v84 row_shr:2 row_mask:0xf bank_mask:0xf bound_ctrl:0
  s_nop 1
  v_add_f32_dpp v84, v84, v84 row_shr:4 row_mask:0xf bank_mask:0xf bound_ctrl:0
  s_nop 1
  v_add_f32_dpp v84, v84, v84 row_shr:8 row_mask:0xf bank_mask:0xf bound_ctrl:0
  s_nop 1
  v_add_f32_dpp v84, v84, v84 row_bcast:15 row_mask:0xa bank_mask:0xf
  v_cvt_pk_bf16_f32 v86, 0, v84
  v_mul_f32 v86, s33, v86
  v_exp_f32 v86, v86
  s_nop 0
  v_add_f32 v86, 1.0, v86
  v_rcp_f32 v86, v86
  s_nop 0
  v_cvt_pk_bf16_f32 v86, 0, v86
  v_sub_f32 v87, 1.0, v86
  v_cvt_pk_bf16_f32 v86, v86, v87
  v_mov_b32 v87, s64
  v_lshrrev_b32 v88, 5, v4
  v_lshlrev_b32 v88, 3, v88
  s_lshl_b32 s13, s45, 3
  s_add_u32 s13, s13, 27262976
  s_mov_b32 exec_lo, 0x80000000
  s_mov_b32 exec_hi, 0x80000000
  buffer_store_dwordx2 v[86:87], v88, s[72:75], s13 offen sc1
  s_mov_b64 exec, -1
  s_waitcnt lgkmcnt(0)
  s_xor_b64 s[66:67], s[80:81], s[64:65]
  s_xor_b64 s[82:83], s[82:83], s[64:65]
  s_or_b64 s[66:67], s[66:67], s[82:83]
  s_xor_b64 s[84:85], s[84:85], s[64:65]
  s_or_b64 s[66:67], s[66:67], s[84:85]
  s_xor_b64 s[86:87], s[86:87], s[64:65]
  s_or_b64 s[66:67], s[66:67], s[86:87]
  s_xor_b64 s[88:89], s[88:89], s[64:65]
  s_or_b64 s[66:67], s[66:67], s[88:89]
  s_xor_b64 s[90:91], s[90:91], s[64:65]
  s_or_b64 s[66:67], s[66:67], s[90:91]
  s_xor_b64 s[92:93], s[92:93], s[64:65]
  s_or_b64 s[66:67], s[66:67], s[92:93]
  s_xor_b64 s[94:95], s[94:95], s[64:65]
  s_or_b64 s[66:67], s[66:67], s[94:95]
  s_cbranch_scc1 L_pp_100
L_pd_101:
  s_cmp_eq_u32 s11, 7
  s_cselect_b32 s14, 0, 9
  s_mov_b32 s68, 0
L_lt_99:
  ds_read_b32 v28, v23
  s_add_u32 s68, s68, 1
  s_cmp_gt_u32 s68, 0x40000
  s_cselect_b32 s13, 0, s14
  s_sleep 1
  s_waitcnt lgkmcnt(0)
  v_cmp_gt_u32 vcc, s13, v28
  s_cbranch_vccnz L_lt_99
  buffer_load_dwordx4 v[64:67], v5, s[72:75], s71 offen sc1
  buffer_load_dwordx4 v[68:71], v5, s[72:75], s98 offen sc1
  buffer_load_dwordx4 v[72:75], v5, s[72:75], s99 offen sc1
  s_waitcnt lgkmcnt(0)
  v_mov_b32 v8, v5
  v_mov_b32 v26, 5
  s_cmp_eq_u32 s11, 7
  s_cbranch_scc1 L_sf_103
  s_mov_b32 s68, 0
L_sw_105:
  ds_read_b32 v28, v25 offset:16
  s_add_u32 s68, s68, 1
  s_cmp_gt_u32 s68, 0x40000
  s_cselect_b32 s13, 0, 11
  s_waitcnt lgkmcnt(0)
  v_cmp_gt_u32 vcc, s13, v28
  s_cbranch_vccnz L_sw_105
  s_setprio 2
  ds_read_b128 v[96:99], v22 offset:0
  ds_read_b128 v[100:103], v22 offset:1024
  s_waitcnt lgkmcnt(1)
  v_lshlrev_b32 v112, 16, v96
  v_and_b32 v113, s32, v96
  v_lshlrev_b32 v114, 16, v97
  v_and_b32 v115, s32, v97
  v_lshlrev_b32 v116, 16, v98
  v_and_b32 v117, s32, v98
  v_lshlrev_b32 v118, 16, v99
  v_and_b32 v119, s32, v99
  v_mul_f32 v120, s33, v112
  v_mul_f32 v121, s33, v113
  v_mul_f32 v122, s33, v114
  v_mul_f32 v123, s33, v115
  v_mul_f32 v124, s33, v116
  v_mul_f32 v125, s33, v117
  v_mul_f32 v126, s33, v118
  v_mul_f32 v127, s33, v119
  v_exp_f32 v120, v120
  v_exp_f32 v121, v121
  v_exp_f32 v122, v122
  v_exp_f32 v123, v123
  v_exp_f32 v124, v124
  v_exp_f32 v125, v125
  v_exp_f32 v126, v126
  v_exp_f32 v127, v127
  v_add_f32 v120, 1.0, v120
  v_add_f32 v121, 1.0, v121
  v_add_f32 v122, 1.0, v122
  v_add_f32 v123, 1.0, v123
  v_add_f32 v124, 1.0, v124
  v_add_f32 v125, 1.0, v125
  v_add_f32 v126, 1.0, v126
  v_add_f32 v127, 1.0, v127
  v_rcp_f32 v120, v120
  v_rcp_f32 v121, v121
  v_rcp_f32 v122, v122
  v_rcp_f32 v123, v123
  v_rcp_f32 v124, v124
  v_rcp_f32 v125, v125
  v_rcp_f32 v126, v126
  v_rcp_f32 v127, v127
  v_mul_f32 v112, v112, v120
  v_mul_f32 v113, v113, v121
  v_mul_f32 v114, v114, v122
  v_mul_f32 v115, v115, v123
  v_mul_f32 v116, v116, v124
  v_mul_f32 v117, v117, v125
  v_mul_f32 v118, v118, v126
  v_mul_f32 v119, v119, v127
  s_add_u32 s15, s78, 0
  v_cvt_pk_bf16_f32 v96, v112, v113
  v_cvt_pk_bf16_f32 v97, v114, v115
  v_cvt_pk_bf16_f32 v98, v116, v117
  v_cvt_pk_bf16_f32 v99, v118, v119
  buffer_store_dwordx4 v[96:99], v8, s[72:75], s15 offen offset:0 sc1
  ds_read_b32 v28, v23 offset:0
  s_waitcnt lgkmcnt(1)
  v_lshlrev_b32 v112, 16, v100
  v_and_b32 v113, s32, v100
  v_lshlrev_b32 v114, 16, v101
  v_and_b32 v115, s32, v101
  v_lshlrev_b32 v116, 16, v102
  v_and_b32 v117, s32, v102
  v_lshlrev_b32 v118, 16, v103
  v_and_b32 v119, s32, v103
  v_mul_f32 v120, s33, v112
  v_mul_f32 v121, s33, v113
  v_mul_f32 v122, s33, v114
  v_mul_f32 v123, s33, v115
  v_mul_f32 v124, s33, v116
  v_mul_f32 v125, s33, v117
  v_mul_f32 v126, s33, v118
  v_mul_f32 v127, s33, v119
  v_exp_f32 v120, v120
  v_exp_f32 v121, v121
  v_exp_f32 v122, v122
  v_exp_f32 v123, v123
  v_exp_f32 v124, v124
  v_exp_f32 v125, v125
  v_exp_f32 v126, v126
  v_exp_f32 v127, v127
  v_add_f32 v120, 1.0, v120
  v_add_f32 v121, 1.0, v121
  v_add_f32 v122, 1.0, v122
  v_add_f32 v123, 1.0, v123
  v_add_f32 v124, 1.0, v124
  v_add_f32 v125, 1.0, v125
  v_add_f32 v126, 1.0, v126
  v_add_f32 v127, 1.0, v127
  v_rcp_f32 v120, v120
  v_rcp_f32 v121, v121
  v_rcp_f32 v122, v122
  v_rcp_f32 v123, v123
  v_rcp_f32 v124, v124
  v_rcp_f32 v125, v125
  v_rcp_f32 v126, v126
  v_rcp_f32 v127, v127
  v_mul_f32 v112, v112, v120
  v_mul_f32 v113, v113, v121
  v_mul_f32 v114, v114, v122
  v_mul_f32 v115, v115, v123
  v_mul_f32 v116, v116, v124
  v_mul_f32 v117, v117, v125
  v_mul_f32 v118, v118, v126
  v_mul_f32 v119, v119, v127
  s_add_u32 s15, s78, 0
  v_cvt_pk_bf16_f32 v100, v112, v113
  v_cvt_pk_bf16_f32 v101, v114, v115
  v_cvt_pk_bf16_f32 v102, v116, v117
  v_cvt_pk_bf16_f32 v103, v118, v119
  buffer_store_dwordx4 v[100:103], v8, s[72:75], s15 offen offset:1024 sc1
  s_waitcnt lgkmcnt(0)
  v_cmp_gt_u32 vcc, 11, v28
  s_cbranch_vccnz L_sp_106
L_sd_107:
  ds_read_b128 v[104:107], v22 offset:2048
  ds_read_b128 v[108:111], v22 offset:3072
L_sb_104:
  v_subrev_u32 v23, 16, v24
  s_waitcnt vmcnt(2)
  v_xor_b32 v74, s64, v67
  v_xor_b32 v67, s64, v71
  v_xor_b32 v71, s64, v75
  v_or3_b32 v74, v74, v67, v71
  v_cmp_ne_u32 vcc, 0, v74
  s_cbranch_vccnz L_ip_109
L_id_110:
  v_mov_b32 v67, v72
  v_mov_b32 v71, v73
  ds_write_b128 v9, v[64:67]
  ds_write_b128 v9, v[68:71] offset:4608
  ds_write_b32 v25, v26
  v_add_u32 v26, 1, v26
  s_waitcnt lgkmcnt(4)
  v_lshlrev_b32 v112, 16, v104
  v_and_b32 v113, s32, v104
  v_lshlrev_b32 v114, 16, v105
  v_and_b32 v115, s32, v105
  v_lshlrev_b32 v116, 16, v106
  v_and_b32 v117, s32, v106
  v_lshlrev_b32 v118, 16, v107
  v_and_b32 v119, s32, v107
  v_mul_f32 v120, s33, v112
  ds_read_b32 v28, v24 offset:0
  v_mul_f32 v121, s33, v113
  v_mul_f32 v122, s33, v114
  v_mul_f32 v123, s33, v115
  v_mul_f32 v124, s33, v116
  v_mul_f32 v125, s33, v117
  v_mul_f32 v126, s33, v118
  v_mul_f32 v127, s33, v119
  v_exp_f32 v120, v120
  v_exp_f32 v121, v121
  v_exp_f32 v122, v122
  v_exp_f32 v123, v123
  v_exp_f32 v124, v124
  v_exp_f32 v125, v125
  v_exp_f32 v126, v126
  v_exp_f32 v127, v127
  v_add_f32 v120, 1.0, v120
  v_add_f32 v121, 1.0, v121
  v_add_f32 v122, 1.0, v122
  v_add_f32 v123, 1.0, v123
  v_add_f32 v124, 1.0, v124
  v_add_f32 v125, 1.0, v125
  v_add_f32 v126, 1.0, v126
  v_add_f32 v127, 1.0, v127
  v_rcp_f32 v120, v120
  v_rcp_f32 v121, v121
  v_rcp_f32 v122, v122
  v_rcp_f32 v123, v123
  v_rcp_f32 v124, v124
  v_rcp_f32 v125, v125
  v_rcp_f32 v126, v126
  v_rcp_f32 v127, v127
  v_mul_f32 v112, v112, v120
  v_mul_f32 v113, v113, v121
  v_mul_f32 v114, v114, v122
  v_mul_f32 v115, v115, v123
  v_mul_f32 v116, v116, v124
  v_mul_f32 v117, v117, v125
  v_mul_f32 v118, v118, v126
  v_mul_f32 v119, v119, v127
  s_add_u32 s15, s78, 57344
  v_cvt_pk_bf16_f32 v104, v112, v113
  v_cvt_pk_bf16_f32 v105, v114, v115
  v_cvt_pk_bf16_f32 v106, v116, v117
  v_cvt_pk_bf16_f32 v107, v118, v119
  buffer_store_dwordx4 v[104:107], v8, s[72:75], s15 offen offset:0 sc1
  s_waitcnt lgkmcnt(4)
  v_lshlrev_b32 v112, 16, v108
  v_and_b32 v113, s32, v108
  v_lshlrev_b32 v114, 16, v109
  v_and_b32 v115, s32, v109
  s_waitcnt lgkmcnt(0)
  v_cmp_gt_u32 vcc, 5, v28
  s_cbranch_vccnz L_sp_112
L_sd_113:
  ds_read_b128 v[64:67], v12 offset:3584
  ds_read_b128 v[68:71], v12 offset:3072
  ds_read_b128 v[72:75], v12 offset:2560
  ds_read_b128 v[76:79], v12 offset:2048
  ds_read_b128 v[80:83], v12 offset:1536
  ds_read_b128 v[84:87], v12 offset:1024
  ds_read_b128 v[88:91], v12 offset:512
  ds_read_b128 v[92:95], v12 offset:0
  v_lshlrev_b32 v116, 16, v110
  v_and_b32 v117, s32, v110
  v_lshlrev_b32 v118, 16, v111
  v_and_b32 v119, s32, v111
  v_mul_f32 v120, s33, v112
  v_mul_f32 v121, s33, v113
  v_mul_f32 v122, s33, v114
  v_mul_f32 v123, s33, v115
  v_mul_f32 v124, s33, v116
  v_mul_f32 v125, s33, v117
  v_mul_f32 v126, s33, v118
  v_mul_f32 v127, s33, v119
  v_exp_f32 v120, v120
  v_exp_f32 v121, v121
  v_exp_f32 v122, v122
  v_exp_f32 v123, v123
  v_exp_f32 v124, v124
  v_exp_f32 v125, v125
  v_exp_f32 v126, v126
  v_exp_f32 v127, v127
  v_add_f32 v120, 1.0, v120
  v_add_f32 v121, 1.0, v121
  v_add_f32 v122, 1.0, v122
  v_add_f32 v123, 1.0, v123
  v_add_f32 v124, 1.0, v124
  v_add_f32 v125, 1.0, v125
  v_add_f32 v126, 1.0, v126
  v_add_f32 v127, 1.0, v127
  v_rcp_f32 v120, v120
  v_rcp_f32 v121, v121
  v_rcp_f32 v122, v122
  v_rcp_f32 v123, v123
  v_rcp_f32 v124, v124
  v_rcp_f32 v125, v125
  v_rcp_f32 v126, v126
  v_rcp_f32 v127, v127
  v_mul_f32 v112, v112, v120
  v_mul_f32 v113, v113, v121
  v_mul_f32 v114, v114, v122
  v_mul_f32 v115, v115, v123
  v_mul_f32 v116, v116, v124
  v_mul_f32 v117, v117, v125
  v_mul_f32 v118, v118, v126
  v_mul_f32 v119, v119, v127
  s_add_u32 s15, s78, 57344
  v_cvt_pk_bf16_f32 v108, v112, v113
  v_cvt_pk_bf16_f32 v109, v114, v115
  v_cvt_pk_bf16_f32 v110, v116, v117
  v_cvt_pk_bf16_f32 v111, v118, v119
  buffer_store_dwordx4 v[108:111], v8, s[72:75], s15 offen offset:1024 sc1
  s_setprio 0
  s_waitcnt lgkmcnt(7)
  v_mfma_f32_16x16x32_bf16 v[56:59], a[24:27], v[64:67], 0
  v_mfma_f32_16x16x32_bf16 v[60:63], a[28:31], v[64:67], 0
  v_mfma_f32_16x16x32_bf16 v[52:55], a[20:23], v[64:67], 0
  v_mfma_f32_16x16x32_bf16 v[48:51], a[16:19], v[64:67], 0
  v_mfma_f32_16x16x32_bf16 v[44:47], a[12:15], v[64:67], 0
  v_mfma_f32_16x16x32_bf16 v[40:43], a[8:11], v[64:67], 0
  ds_read_b128 v[96:99], v12 offset:3648
  v_mfma_f32_16x16x32_bf16 v[36:39], a[4:7], v[64:67], 0
  v_mfma_f32_16x16x32_bf16 v[32:35], a[0:3], v[64:67], 0
  s_waitcnt lgkmcnt(7)
  v_mfma_f32_16x16x32_bf16 v[60:63], a[24:27], v[68:71], v[60:63]
  ds_read_b128 v[100:103], v12 offset:3136
  v_mfma_f32_16x16x32_bf16 v[56:59], a[20:23], v[68:71], v[56:59]
  v_mfma_f32_16x16x32_bf16 v[52:55], a[16:19], v[68:71], v[52:55]
  v_mfma_f32_16x16x32_bf16 v[48:51], a[12:15], v[68:71], v[48:51]
  ds_read_b128 v[104:107], v12 offset:2624
  v_mfma_f32_16x16x32_bf16 v[44:47], a[8:11], v[68:71], v[44:47]
  v_mfma_f32_16x16x32_bf16 v[40:43], a[4:7], v[68:71], v[40:43]
  v_mfma_f32_16x16x32_bf16 v[36:39], a[0:3], v[68:71], v[36:39]
  ds_read_b128 v[108:111], v12 offset:2112
  s_waitcnt lgkmcnt(9)
  v_mfma_f32_16x16x32_bf16 v[60:63], a[20:23], v[72:75], v[60:63]
  s_waitcnt vmcnt(0)
  buffer_store_dword v30, v21, s[72:75], s79 offen offset:1536 sc1
  v_mfma_f32_16x16x32_bf16 v[56:59], a[16:19], v[72:75], v[56:59]
  v_mfma_f32_16x16x32_bf16 v[52:55], a[12:15], v[72:75], v[52:55]
  ds_read_b128 v[112:115], v12 offset:1600
  v_mfma_f32_16x16x32_bf16 v[48:51], a[8:11], v[72:75], v[48:51]
  v_mfma_f32_16x16x32_bf16 v[44:47], a[4:7], v[72:75], v[44:47]
  v_mfma_f32_16x16x32_bf16 v[40:43], a[0:3], v[72:75], v[40:43]
  ds_read_b128 v[116:119], v12 offset:1088
  s_waitcnt lgkmcnt(10)
  v_mfma_f32_16x16x32_bf16 v[60:63], a[16:19], v[76:79], v[60:63]
  v_mfma_f32_16x16x32_bf16 v[56:59], a[12:15], v[76:79], v[56:59]
  v_mfma_f32_16x16x32_bf16 v[52:55], a[8:11], v[76:79], v[52:55]
  ds_read_b128 v[120:123], v12 offset:576
  v_mfma_f32_16x16x32_bf16 v[48:51], a[4:7], v[76:79], v[48:51]
  v_mfma_f32_16x16x32_bf16 v[44:47], a[0:3], v[76:79], v[44:47]
  s_waitcnt lgkmcnt(10)
  v_mfma_f32_16x16x32_bf16 v[60:63], a[12:15], v[80:83], v[60:63]
  ds_read_b128 v[124:127], v12 offset:64
  v_mfma_f32_16x16x32_bf16 v[56:59], a[8:11], v[80:83], v[56:59]
  v_mfma_f32_16x16x32_bf16 v[52:55], a[4:7], v[80:83], v[52:55]
  v_mfma_f32_16x16x32_bf16 v[48:51], a[0:3], v[80:83], v[48:51]
  s_waitcnt lgkmcnt(10)
  v_mfma_f32_16x16x32_bf16 v[60:63], a[8:11], v[84:87], v[60:63]
  v_mfma_f32_16x16x32_bf16 v[56:59], a[4:7], v[84:87], v[56:59]
  v_mfma_f32_16x16x32_bf16 v[52:55], a[0:3], v[84:87], v[52:55]
  s_waitcnt lgkmcnt(9)
  v_mfma_f32_16x16x32_bf16 v[60:63], a[4:7], v[88:91], v[60:63]
  v_mfma_f32_16x16x32_bf16 v[56:59], a[0:3], v[88:91], v[56:59]
  s_waitcnt lgkmcnt(8)
  v_mfma_f32_16x16x32_bf16 v[60:63], a[0:3], v[92:95], v[60:63]
  s_waitcnt lgkmcnt(7)
  v_mfma_f32_16x16x32_bf16 v[56:59], a[56:59], v[96:99], v[56:59]
  v_mfma_f32_16x16x32_bf16 v[60:63], a[60:63], v[96:99], v[60:63]
  v_mfma_f32_16x16x32_bf16 v[52:55], a[52:55], v[96:99], v[52:55]
  v_mfma_f32_16x16x32_bf16 v[48:51], a[48:51], v[96:99], v[48:51]
  v_mfma_f32_16x16x32_bf16 v[44:47], a[44:47], v[96:99], v[44:47]
  v_mfma_f32_16x16x32_bf16 v[40:43], a[40:43], v[96:99], v[40:43]
  ds_read_b128 v[64:67], v12 offset:3712
  v_mfma_f32_16x16x32_bf16 v[36:39], a[36:39], v[96:99], v[36:39]
  v_mfma_f32_16x16x32_bf16 v[32:35], a[32:35], v[96:99], v[32:35]
  s_waitcnt lgkmcnt(7)
  v_mfma_f32_16x16x32_bf16 v[60:63], a[56:59], v[100:103], v[60:63]
  ds_read_b128 v[68:71], v12 offset:3200
  v_mfma_f32_16x16x32_bf16 v[56:59], a[52:55], v[100:103], v[56:59]
  v_mfma_f32_16x16x32_bf16 v[52:55], a[48:51], v[100:103], v[52:55]
  v_mfma_f32_16x16x32_bf16 v[48:51], a[44:47], v[100:103], v[48:51]
  ds_read_b128 v[72:75], v12 offset:2688
  s_load_dwordx16 s[16:31], s[72:73], s61 offset:1536 glc
  s_mov_b32 s70, 1
  v_mov_b32 v20, 2.0
  v_mfma_f32_16x16x32_bf16 v[44:47], a[40:43], v[100:103], v[44:47]
  v_mfma_f32_16x16x32_bf16 v[40:43], a[36:39], v[100:103], v[40:43]
  v_mfma_f32_16x16x32_bf16 v[36:39], a[32:35], v[100:103], v[36:39]
  ds_read_b128 v[76:79], v12 offset:2176
  s_waitcnt lgkmcnt(9)
  v_mfma_f32_16x16x32_bf16 v[60:63], a[52:55], v[104:107], v[60:63]
  v_mfma_f32_16x16x32_bf16 v[56:59], a[48:51], v[104:107], v[56:59]
  v_mfma_f32_16x16x32_bf16 v[52:55], a[44:47], v[104:107], v[52:55]
  ds_read_b128 v[80:83], v12 offset:1664
  v_mfma_f32_16x16x32_bf16 v[48:51], a[40:43], v[104:107], v[48:51]
  v_mfma_f32_16x16x32_bf16 v[44:47], a[36:39], v[104:107], v[44:47]
  v_mfma_f32_16x16x32_bf16 v[40:43], a[32:35], v[104:107], v[40:43]
  ds_read_b128 v[84:87], v12 offset:1152
  s_waitcnt lgkmcnt(10)
  v_mfma_f32_16x16x32_bf16 v[60:63], a[48:51], v[108:111], v[60:63]
  v_mfma_f32_16x16x32_bf16 v[56:59], a[44:47], v[108:111], v[56:59]
  v_mfma_f32_16x16x32_bf16 v[52:55], a[40:43], v[108:111], v[52:55]
  ds_read_b128 v[88:91], v12 offset:640
  v_mfma_f32_16x16x32_bf16 v[48:51], a[36:39], v[108:111], v[48:51]
  s_cmp_eq_u32 s70, 0
  s_cbranch_scc1 L_rbA_8
  s_xor_b64 s[66:67], s[16:17], s[64:65]
  s_xor_b64 s[96:97], s[18:19], s[64:65]
  s_or_b64 s[66:67], s[66:67], s[96:97]
  s_xor_b64 s[96:97], s[20:21], s[64:65]
  s_or_b64 s[66:67], s[66:67], s[96:97]
  s_xor_b64 s[96:97], s[22:23], s[64:65]
  s_or_b64 s[66:67], s[66:67], s[96:97]
  s_xor_b64 s[96:97], s[24:25], s[64:65]
  s_or_b64 s[66:67], s[66:67], s[96:97]
  s_xor_b64 s[96:97], s[26:27], s[64:65]
  s_or_b64 s[66:67], s[66:67], s[96:97]
  s_xor_b64 s[96:97], s[28:29], s[64:65]
  s_or_b64 s[66:67], s[66:67], s[96:97]
  s_cbranch_scc0 L_rgA_8
  s_load_dwordx16 s[16:31], s[72:73], s61 offset:1536 glc
  s_branch L_rbA_8
L_rgA_8:
  s_mov_b32 s70, 0
  v_mov_b32 v20, v5
L_rbA_8:
  buffer_load_dwordx4 a[0:3], v20, s[72:75], s52 offen offset:0 sc1
  v_mfma_f32_16x16x32_bf16 v[44:47], a[32:35], v[108:111], v[44:47]
  s_waitcnt lgkmcnt(10)
  v_mfma_f32_16x16x32_bf16 v[60:63], a[44:47], v[112:115], v[60:63]
  ds_read_b128 v[92:95], v12 offset:128
  v_mfma_f32_16x16x32_bf16 v[56:59], a[40:43], v[112:115], v[56:59]
  v_mfma_f32_16x16x32_bf16 v[52:55], a[36:39], v[112:115], v[52:55]
  v_mfma_f32_16x16x32_bf16 v[48:51], a[32:35], v[112:115], v[48:51]
  buffer_load_dwordx4 a[4:7], v20, s[72:75], s52 offen offset:1024 sc1
  s_waitcnt lgkmcnt(10)
  v_mfma_f32_16x16x32_bf16 v[60:63], a[40:43], v[116:119], v[60:63]
  v_mfma_f32_16x16x32_bf16 v[56:59], a[36:39], v[116:119], v[56:59]
  v_mfma_f32_16x16x32_bf16 v[52:55], a[32:35], v[116:119], v[52:55]
  s_waitcnt lgkmcnt(9)
  v_mfma_f32_16x16x32_bf16 v[60:63], a[36:39], v[120:123], v[60:63]
  v_mfma_f32_16x16x32_bf16 v[56:59], a[32:35], v[120:123], v[56:59]
  s_cmp_eq_u32 s70, 0
  s_cbranch_scc1 L_rbA_9
  s_xor_b64 s[66:67], s[16:17], s[64:65]
  s_xor_b64 s[96:97], s[18:19], s[64:65]
  s_or_b64 s[66:67], s[66:67], s[96:97]
  s_xor_b64 s[96:97], s[20:21], s[64:65]
  s_or_b64 s[66:67], s[66:67], s[96:97]
  s_xor_b64 s[96:97], s[22:23], s[64:65]
  s_or_b64 s[66:67], s[66:67], s[96:97]
  s_xor_b64 s[96:97], s[24:25], s[64:65]
  s_or_b64 s[66:67], s[66:67], s[96:97]
  s_xor_b64 s[96:97], s[26:27], s[64:65]
  s_or_b64 s[66:67], s[66:67], s[96:97]
  s_xor_b64 s[96:97], s[28:29], s[64:65]
  s_or_b64 s[66:67], s[66:67], s[96:97]
  s_cbranch_scc0 L_rgA_9
  s_load_dwordx16 s[16:31], s[72:73], s61 offset:1536 glc
  s_branch L_rbA_9
L_rgA_9:
  buffer_load_dwordx4 a[0:3], v5, s[72:75], s52 offen offset:0 sc1
  buffer_load_dwordx4 a[4:7], v5, s[72:75], s52 offen offset:1024 sc1
  s_mov_b32 s70, 0
  v_mov_b32 v20, v5
L_rbA_9:
  buffer_load_dwordx4 a[8:11], v20, s[72:75], s52 offen offset:2048 sc1
  s_waitcnt lgkmcnt(8)
  v_mfma_f32_16x16x32_bf16 v[60:63], a[32:35], v[124:127], v[60:63]
  s_waitcnt lgkmcnt(7)
  v_mfma_f32_16x16x32_bf16 v[56:59], a[88:91], v[64:67], v[56:59]
  v_mfma_f32_16x16x32_bf16 v[60:63], a[92:95], v[64:67], v[60:63]
  v_mfma_f32_16x16x32_bf16 v[52:55], a[84:87], v[64:67], v[52:55]
  v_mfma_f32_16x16x32_bf16 v[48:51], a[80:83], v[64:67], v[48:51]
  buffer_load_dwordx4 a[12:15], v20, s[72:75], s52 offen offset:3072 sc1
  v_mfma_f32_16x16x32_bf16 v[44:47], a[76:79], v[64:67], v[44:47]
  v_mfma_f32_16x16x32_bf16 v[40:43], a[72:75], v[64:67], v[40:43]
  ds_read_b128 v[96:99], v12 offset:3776
  v_mfma_f32_16x16x32_bf16 v[36:39], a[68:71], v[64:67], v[36:39]
  v_mfma_f32_16x16x32_bf16 v[32:35], a[64:67], v[64:67], v[32:35]
  s_waitcnt lgkmcnt(7)
  v_mfma_f32_16x16x32_bf16 v[60:63], a[88:91], v[68:71], v[60:63]
  s_cmp_eq_u32 s70, 0
  s_cbranch_scc1 L_rbA_10
  s_xor_b64 s[66:67], s[16:17], s[64:65]
  s_xor_b64 s[96:97], s[18:19], s[64:65]
  s_or_b64 s[66:67], s[66:67], s[96:97]
  s_xor_b64 s[96:97], s[20:21], s[64:65]
  s_or_b64 s[66:67], s[66:67], s[96:97]
  s_xor_b64 s[96:97], s[22:23], s[64:65]
  s_or_b64 s[66:67], s[66:67], s[96:97]
  s_xor_b64 s[96:97], s[24:25], s[64:65]
  s_or_b64 s[66:67], s[66:67], s[96:97]
  s_xor_b64 s[96:97], s[26:27], s[64:65]
  s_or_b64 s[66:67], s[66:67], s[96:97]
  s_xor_b64 s[96:97], s[28:29], s[64:65]
  s_or_b64 s[66:67], s[66:67], s[96:97]
  s_cbranch_scc0 L_rgA_10
  s_load_dwordx16 s[16:31], s[72:73], s61 offset:1536 glc
  s_branch L_rbA_10
L_rgA_10:
  buffer_load_dwordx4 a[0:3], v5, s[72:75], s52 offen offset:0 sc1
  buffer_load_dwordx4 a[4:7], v5, s[72:75], s52 offen offset:1024 sc1
  buffer_load_dwordx4 a[8:11], v5, s[72:75], s52 offen offset:2048 sc1
  buffer_load_dwordx4 a[12:15], v5, s[72:75], s52 offen offset:3072 sc1
  s_mov_b32 s70, 0
  v_mov_b32 v20, v5
L_rbA_10:
  buffer_load_dwordx4 a[16:19], v20, s[72:75], s53 offen offset:0 sc1
  ds_read_b128 v[100:103], v12 offset:3264
  v_mfma_f32_16x16x32_bf16 v[56:59], a[84:87], v[68:71], v[56:59]
  v_mfma_f32_16x16x32_bf16 v[52:55], a[80:83], v[68:71], v[52:55]
  v_mfma_f32_16x16x32_bf16 v[48:51], a[76:79], v[68:71], v[48:51]
  ds_read_b128 v[104:107], v12 offset:2752
  v_mfma_f32_16x16x32_bf16 v[44:47], a[72:75], v[68:71], v[44:47]
  v_mfma_f32_16x16x32_bf16 v[40:43], a[68:71], v[68:71], v[40:43]
  buffer_load_dwordx4 a[20:23], v20, s[72:75], s53 offen offset:1024 sc1
  v_mfma_f32_16x16x32_bf16 v[36:39], a[64:67], v[68:71], v[36:39]
  ds_read_b128 v[108:111], v12 offset:2240
  s_waitcnt lgkmcnt(9)
  v_mfma_f32_16x16x32_bf16 v[60:63], a[84:87], v[72:75], v[60:63]
  v_mfma_f32_16x16x32_bf16 v[56:59], a[80:83], v[72:75], v[56:59]
  v_mfma_f32_16x16x32_bf16 v[52:55], a[76:79], v[72:75], v[52:55]
  ds_read_b128 v[112:115], v12 offset:1728
  v_mfma_f32_16x16x32_bf16 v[48:51], a[72:75], v[72:75], v[48:51]
  buffer_load_dwordx4 a[24:27], v20, s[72:75], s53 offen offset:2048 sc1
  v_mfma_f32_16x16x32_bf16 v[44:47], a[68:71], v[72:75], v[44:47]
  v_mfma_f32_16x16x32_bf16 v[40:43], a[64:67], v[72:75], v[40:43]
  s_cmp_eq_u32 s70, 0
  s_cbranch_scc1 L_rbA_11
  s_xor_b64 s[66:67], s[16:17], s[64:65]
  s_xor_b64 s[96:97], s[18:19], s[64:65]
  s_or_b64 s[66:67], s[66:67], s[96:97]
  s_xor_b64 s[96:97], s[20:21], s[64:65]
  s_or_b64 s[66:67], s[66:67], s[96:97]
  s_xor_b64 s[96:97], s[22:23], s[64:65]
  s_or_b64 s[66:67], s[66:67], s[96:97]
  s_xor_b64 s[96:97], s[24:25], s[64:65]
  s_or_b64 s[66:67], s[66:67], s[96:97]
  s_xor_b64 s[96:97], s[26:27], s[64:65]
  s_or_b64 s[66:67], s[66:67], s[96:97]
  s_xor_b64 s[96:97], s[28:29], s[64:65]
  s_or_b64 s[66:67], s[66:67], s[96:97]
  s_cbranch_scc0 L_rgA_11
  s_load_dwordx16 s[16:31], s[72:73], s61 offset:1536 glc
  s_branch L_rbA_11
L_rgA_11:
  buffer_load_dwordx4 a[0:3], v5, s[72:75], s52 offen offset:0 sc1
  buffer_load_dwordx4 a[4:7], v5, s[72:75], s52 offen offset:1024 sc1
  buffer_load_dwordx4 a[8:11], v5, s[72:75], s52 offen offset:2048 sc1
  buffer_load_dwordx4 a[12:15], v5, s[72:75], s52 offen offset:3072 sc1
  buffer_load_dwordx4 a[16:19], v5, s[72:75], s53 offen offset:0 sc1
  buffer_load_dwordx4 a[20:23], v5, s[72:75], s53 offen offset:1024 sc1
  buffer_load_dwordx4 a[24:27], v5, s[72:75], s53 offen offset:2048 sc1
  s_mov_b32 s70, 0
  v_mov_b32 v20, v5
L_rbA_11:
  ds_read_b128 v[116:119], v12 offset:1216
  s_waitcnt lgkmcnt(10)
  v_mfma_f32_16x16x32_bf16 v[60:63], a[80:83], v[76:79], v[60:63]
  v_mfma_f32_16x16x32_bf16 v[56:59], a[76:79], v[76:79], v[56:59]
  v_mfma_f32_16x16x32_bf16 v[52:55], a[72:75], v[76:79], v[52:55]
  buffer_load_dwordx4 a[28:31], v20, s[72:75], s53 offen offset:3072 sc1
  ds_read_b128 v[120:123], v12 offset:704
  v_mfma_f32_16x16x32_bf16 v[48:51], a[68:71], v[76:79], v[48:51]
  v_mfma_f32_16x16x32_bf16 v[44:47], a[64:67], v[76:79], v[44:47]
  s_waitcnt lgkmcnt(10)
  v_mfma_f32_16x16x32_bf16 v[60:63], a[76:79], v[80:83], v[60:63]
  ds_read_b128 v[124:127], v12 offset:192
  v_mfma_f32_16x16x32_bf16 v[56:59], a[72:75], v[80:83], v[56:59]
  s_setprio 1
  v_mfma_f32_16x16x32_bf16 v[52:55], a[68:71], v[80:83], v[52:55]
  buffer_load_dwordx4 a[32:35], v20, s[72:75], s54 offen offset:0 sc1
  v_mfma_f32_16x16x32_bf16 v[48:51], a[64:67], v[80:83], v[48:51]
  s_waitcnt lgkmcnt(10)
  v_mfma_f32_16x16x32_bf16 v[60:63], a[72:75], v[84:87], v[60:63]
  v_mfma_f32_16x16x32_bf16 v[56:59], a[68:71], v[84:87], v[56:59]
  v_mfma_f32_16x16x32_bf16 v[52:55], a[64:67], v[84:87], v[52:55]
  s_waitcnt lgkmcnt(9)
  v_mfma_f32_16x16x32_bf16 v[60:63], a[68:71], v[88:91], v[60:63]
  buffer_load_dwordx4 a[36:39], v20, s[72:75], s54 offen offset:1024 sc1
  v_mfma_f32_16x16x32_bf16 v[56:59], a[64:67], v[88:91], v[56:59]
  s_waitcnt lgkmcnt(8)
  v_mfma_f32_16x16x32_bf16 v[60:63], a[64:67], v[92:95], v[60:63]
  s_waitcnt lgkmcnt(7)
  v_mfma_f32_16x16x32_bf16 v[56:59], a[120:123], v[96:99], v[56:59]
  s_cmp_eq_u32 s70, 0
  s_cbranch_scc1 L_rbA_12
  s_xor_b64 s[66:67], s[16:17], s[64:65]
  s_xor_b64 s[96:97], s[18:19], s[64:65]
  s_or_b64 s[66:67], s[66:67], s[96:97]
  s_xor_b64 s[96:97], s[20:21], s[64:65]
  s_or_b64 s[66:67], s[66:67], s[96:97]
  s_xor_b64 s[96:97], s[22:23], s[64:65]
  s_or_b64 s[66:67], s[66:67], s[96:97]
  s_xor_b64 s[96:97], s[24:25], s[64:65]
  s_or_b64 s[66:67], s[66:67], s[96:97]
  s_xor_b64 s[96:97], s[26:27], s[64:65]
  s_or_b64 s[66:67], s[66:67], s[96:97]
  s_xor_b64 s[96:97], s[28:29], s[64:65]
  s_or_b64 s[66:67], s[66:67], s[96:97]
  s_cbranch_scc0 L_rgA_12
  s_load_dwordx16 s[16:31], s[72:73], s61 offset:1536 glc
  s_branch L_rbA_12
L_rgA_12:
  buffer_load_dwordx4 a[0:3], v5, s[72:75], s52 offen offset:0 sc1
  buffer_load_dwordx4 a[4:7], v5, s[72:75], s52 offen offset:1024 sc1
  buffer_load_dwordx4 a[8:11], v5, s[72:75], s52 offen offset:2048 sc1
  buffer_load_dwordx4 a[12:15], v5, s[72:75], s52 offen offset:3072 sc1
  buffer_load_dwordx4 a[16:19], v5, s[72:75], s53 offen offset:0 sc1
  buffer_load_dwordx4 a[20:23], v5, s[72:75], s53 offen offset:1024 sc1
  buffer_load_dwordx4 a[24:27], v5, s[72:75], s53 offen offset:2048 sc1
  buffer_load_dwordx4 a[28:31], v5, s[72:75], s53 offen offset:3072 sc1
  buffer_load_dwordx4 a[32:35], v5, s[72:75], s54 offen offset:0 sc1
  buffer_load_dwordx4 a[36:39], v5, s[72:75], s54 offen offset:1024 sc1
  s_mov_b32 s70, 0
  v_mov_b32 v20, v5
L_rbA_12:
  v_mfma_f32_16x16x32_bf16 v[60:63], a[124:127], v[96:99], v[60:63]
  v_mfma_f32_16x16x32_bf16 v[52:55], a[116:119], v[96:99], v[52:55]
  buffer_load_dwordx4 a[40:43], v20, s[72:75], s54 offen offset:2048 sc1
  v_mfma_f32_16x16x32_bf16 v[48:51], a[112:115], v[96:99], v[48:51]
  v_mfma_f32_16x16x32_bf16 v[44:47], a[108:111], v[96:99], v[44:47]
  v_mfma_f32_16x16x32_bf16 v[40:43], a[104:107], v[96:99], v[40:43]
  v_mfma_f32_16x16x32_bf16 v[36:39], a[100:103], v[96:99], v[36:39]
  v_mfma_f32_16x16x32_bf16 v[32:35], a[96:99], v[96:99], v[32:35]
  buffer_load_dwordx4 a[44:47], v20, s[72:75], s54 offen offset:3072 sc1
  s_waitcnt lgkmcnt(6)
  v_mfma_f32_16x16x32_bf16 v[60:63], a[120:123], v[100:103], v[60:63]
  v_mfma_f32_16x16x32_bf16 v[56:59], a[116:119], v[100:103], v[56:59]
  v_mfma_f32_16x16x32_bf16 v[52:55], a[112:115], v[100:103], v[52:55]
  ds_write_b128 v22, v[32:35] offset:16384
  v_mfma_f32_16x16x32_bf16 v[48:51], a[108:111], v[100:103], v[48:51]
  v_mfma_f32_16x16x32_bf16 v[44:47], a[104:107], v[100:103], v[44:47]
  buffer_load_dwordx4 a[48:51], v20, s[72:75], s55 offen offset:0 sc1
  v_mfma_f32_16x16x32_bf16 v[40:43], a[100:103], v[100:103], v[40:43]
  v_mfma_f32_16x16x32_bf16 v[36:39], a[96:99], v[100:103], v[36:39]
  s_waitcnt lgkmcnt(6)
  v_mfma_f32_16x16x32_bf16 v[60:63], a[116:119], v[104:107], v[60:63]
  v_mfma_f32_16x16x32_bf16 v[56:59], a[112:115], v[104:107], v[56:59]
  v_mfma_f32_16x16x32_bf16 v[52:55], a[108:111], v[104:107], v[52:55]
  buffer_load_dwordx4 a[52:55], v20, s[72:75], s55 offen offset:1024 sc1
  ds_write_b128 v22, v[36:39] offset:17408
  v_mfma_f32_16x16x32_bf16 v[48:51], a[104:107], v[104:107], v[48:51]
  v_mfma_f32_16x16x32_bf16 v[44:47], a[100:103], v[104:107], v[44:47]
  v_mfma_f32_16x16x32_bf16 v[40:43], a[96:99], v[104:107], v[40:43]
  s_cmp_eq_u32 s70, 0
  s_cbranch_scc1 L_rbA_13
  s_xor_b64 s[66:67], s[16:17], s[64:65]
  s_xor_b64 s[96:97], s[18:19], s[64:65]
  s_or_b64 s[66:67], s[66:67], s[96:97]
  s_xor_b64 s[96:97], s[20:21], s[64:65]
  s_or_b64 s[66:67], s[66:67], s[96:97]
  s_xor_b64 s[96:97], s[22:23], s[64:65]
  s_or_b64 s[66:67], s[66:67], s[96:97]
  s_xor_b64 s[96:97], s[24:25], s[64:65]
  s_or_b64 s[66:67], s[66:67], s[96:97]
  s_xor_b64 s[96:97], s[26:27], s[64:65]
  s_or_b64 s[66:67], s[66:67], s[96:97]
  s_xor_b64 s[96:97], s[28:29], s[64:65]
  s_or_b64 s[66:67], s[66:67], s[96:97]
  s_cbranch_scc0 L_rgA_13
  s_load_dwordx16 s[16:31], s[72:73], s61 offset:1536 glc
  s_branch L_rbA_13
L_rgA_13:
  buffer_load_dwordx4 a[0:3], v5, s[72:75], s52 offen offset:0 sc1
  buffer_load_dwordx4 a[4:7], v5, s[72:75], s52 offen offset:1024 sc1
  buffer_load_dwordx4 a[8:11], v5, s[72:75], s52 offen offset:2048 sc1
  buffer_load_dwordx4 a[12:15], v5, s[72:75], s52 offen offset:3072 sc1
  buffer_load_dwordx4 a[16:19], v5, s[72:75], s53 offen offset:0 sc1
  buffer_load_dwordx4 a[20:23], v5, s[72:75], s53 offen offset:1024 sc1
  buffer_load_dwordx4 a[24:27], v5, s[72:75], s53 offen offset:2048 sc1
  buffer_load_dwordx4 a[28:31], v5, s[72:75], s53 offen offset:3072 sc1
  buffer_load_dwordx4 a[32:35], v5, s[72:75], s54 offen offset:0 sc1
  buffer_load_dwordx4 a[36:39], v5, s[72:75], s54 offen offset:1024 sc1
  buffer_load_dwordx4 a[40:43], v5, s[72:75], s54 offen offset:2048 sc1
  buffer_load_dwordx4 a[44:47], v5, s[72:75], s54 offen offset:3072 sc1
  buffer_load_dwordx4 a[48:51], v5, s[72:75], s55 offen offset:0 sc1
  buffer_load_dwordx4 a[52:55], v5, s[72:75], s55 offen offset:1024 sc1
  s_mov_b32 s70, 0
  v_mov_b32 v20, v5
L_rbA_13:
  s_waitcnt lgkmcnt(6)
  v_mfma_f32_16x16x32_bf16 v[60:63], a[112:115], v[108:111], v[60:63]
  v_mfma_f32_16x16x32_bf16 v[56:59], a[108:111], v[108:111], v[56:59]
  buffer_load_dwordx4 a[56:59], v20, s[72:75], s55 offen offset:2048 sc1
  v_mfma_f32_16x16x32_bf16 v[52:55], a[104:107], v[108:111], v[52:55]
  ds_write_b128 v22, v[40:43] offset:18432
  v_mfma_f32_16x16x32_bf16 v[48:51], a[100:103], v[108:111], v[48:51]
  ds_read_b32 v28, v23 offset:0
  v_mfma_f32_16x16x32_bf16 v[44:47], a[96:99], v[108:111], v[44:47]
  s_waitcnt lgkmcnt(7)
  v_mfma_f32_16x16x32_bf16 v[60:63], a[108:111], v[112:115], v[60:63]
  v_mfma_f32_16x16x32_bf16 v[56:59], a[104:107], v[112:115], v[56:59]
  buffer_load_dwordx4 a[60:63], v20, s[72:75], s55 offen offset:3072 sc1
  v_mfma_f32_16x16x32_bf16 v[52:55], a[100:103], v[112:115], v[52:55]
  ds_write_b128 v22, v[44:47] offset:19456
  v_mfma_f32_16x16x32_bf16 v[48:51], a[96:99], v[112:115], v[48:51]
  s_waitcnt lgkmcnt(1)
  v_cmp_gt_u32 vcc, 19, v28
  s_cbranch_vccnz L_sp_115
L_sd_116:
  v_mfma_f32_16x16x32_bf16 v[60:63], a[104:107], v[116:119], v[60:63]
  ds_read_b64_tr_b16 v[32:33], v14 offset:0
  ds_read_b64_tr_b16 v[34:35], v14 offset:1024
  v_mfma_f32_16x16x32_bf16 v[56:59], a[100:103], v[116:119], v[56:59]
  v_mfma_f32_16x16x32_bf16 v[52:55], a[96:99], v[116:119], v[52:55]
  buffer_load_dwordx4 a[64:67], v20, s[72:75], s56 offen offset:0 sc1
  ds_write_b128 v22, v[48:51] offset:0
  ds_read_b64_tr_b16 v[36:37], v15 offset:0
  ds_read_b64_tr_b16 v[38:39], v15 offset:1024
  v_mfma_f32_16x16x32_bf16 v[60:63], a[100:103], v[120:123], v[60:63]
  v_mfma_f32_16x16x32_bf16 v[56:59], a[96:99], v[120:123], v[56:59]
  ds_read_b64_tr_b16 v[40:41], v14 offset:2048
  ds_read_b64_tr_b16 v[42:43], v14 offset:3072
  v_mfma_f32_16x16x32_bf16 v[60:63], a[96:99], v[124:127], v[60:63]
  ds_write_b128 v22, v[52:55] offset:1024
  s_setprio 2
  s_lshl3_add_u32 s14, s69, s11
  s_lshl2_add_u32 s14, s14, s6
  s_lshl_b32 s14, s14, 6
  s_add_u32 s76, s14, 28573696
  s_nop 3
  ds_write_b128 v22, v[56:59] offset:2048
  s_nop 3
  ds_write_b128 v22, v[60:63] offset:3072
  ds_write_b32 v25, v26
  v_add_u32 v26, 1, v26
  v_mov_b32 v26, 8
  s_cmp_eq_u32 s70, 0
  s_cbranch_scc1 L_rbA_14
  s_xor_b64 s[66:67], s[16:17], s[64:65]
  s_xor_b64 s[96:97], s[18:19], s[64:65]
  s_or_b64 s[66:67], s[66:67], s[96:97]
  s_xor_b64 s[96:97], s[20:21], s[64:65]
  s_or_b64 s[66:67], s[66:67], s[96:97]
  s_xor_b64 s[96:97], s[22:23], s[64:65]
  s_or_b64 s[66:67], s[66:67], s[96:97]
  s_xor_b64 s[96:97], s[24:25], s[64:65]
  s_or_b64 s[66:67], s[66:67], s[96:97]
  s_xor_b64 s[96:97], s[26:27], s[64:65]
  s_or_b64 s[66:67], s[66:67], s[96:97]
  s_xor_b64 s[96:97], s[28:29], s[64:65]
  s_or_b64 s[66:67], s[66:67], s[96:97]
  s_cbranch_scc1 L_rpA_14
L_rgA_14:
  s_waitcnt vmcnt(24)
  buffer_load_dwordx4 a[0:3], v5, s[72:75], s52 offen offset:0 sc1
  buffer_load_dwordx4 a[4:7], v5, s[72:75], s52 offen offset:1024 sc1
  buffer_load_dwordx4 a[8:11], v5, s[72:75], s52 offen offset:2048 sc1
  buffer_load_dwordx4 a[12:15], v5, s[72:75], s52 offen offset:3072 sc1
  buffer_load_dwordx4 a[16:19], v5, s[72:75], s53 offen offset:0 sc1
  buffer_load_dwordx4 a[20:23], v5, s[72:75], s53 offen offset:1024 sc1
  buffer_load_dwordx4 a[24:27], v5, s[72:75], s53 offen offset:2048 sc1
  buffer_load_dwordx4 a[28:31], v5, s[72:75], s53 offen offset:3072 sc1
  buffer_load_dwordx4 a[32:35], v5, s[72:75], s54 offen offset:0 sc1
  buffer_load_dwordx4 a[36:39], v5, s[72:75], s54 offen offset:1024 sc1
  buffer_load_dwordx4 a[40:43], v5, s[72:75], s54 offen offset:2048 sc1
  buffer_load_dwordx4 a[44:47], v5, s[72:75], s54 offen offset:3072 sc1
  buffer_load_dwordx4 a[48:51], v5, s[72:75], s55 offen offset:0 sc1
  buffer_load_dwordx4 a[52:55], v5, s[72:75], s55 offen offset:1024 sc1
  buffer_load_dwordx4 a[56:59], v5, s[72:75], s55 offen offset:2048 sc1
  buffer_load_dwordx4 a[60:63], v5, s[72:75], s55 offen offset:3072 sc1
  buffer_load_dwordx4 a[64:67], v5, s[72:75], s56 offen offset:0 sc1
  s_mov_b32 s70, 0
  v_mov_b32 v20, v5
L_rbA_14:
  s_setprio 2
  s_waitcnt vmcnt(16) lgkmcnt(9)
  v_mfma_f32_32x32x16_bf16 v[64:79], v[32:35], a[0:3], 0
  ds_read_b64_tr_b16 v[44:45], v15 offset:2048
  ds_read_b64_tr_b16 v[46:47], v15 offset:3072
  buffer_load_dwordx4 a[68:71], v20, s[72:75], s56 offen offset:1024 sc1
  s_waitcnt lgkmcnt(8)
  v_mfma_f32_32x32x16_bf16 v[80:95], v[36:39], a[0:3], 0
  ds_read_b64_tr_b16 v[48:49], v14 offset:4096
  ds_read_b64_tr_b16 v[50:51], v14 offset:5120
  s_waitcnt vmcnt(16) lgkmcnt(8)
  v_mfma_f32_32x32x16_bf16 v[64:79], v[40:43], a[4:7], v[64:79]
  ds_read_b64_tr_b16 v[52:53], v15 offset:4096
  ds_read_b64_tr_b16 v[54:55], v15 offset:5120
  buffer_load_dwordx4 a[72:75], v20, s[72:75], s56 offen offset:2048 sc1
  s_waitcnt lgkmcnt(4)
  v_mfma_f32_32x32x16_bf16 v[80:95], v[44:47], a[4:7], v[80:95]
  ds_read_b64_tr_b16 v[56:57], v14 offset:6144
  ds_read_b64_tr_b16 v[58:59], v14 offset:7168
  s_waitcnt vmcnt(16) lgkmcnt(4)
  v_mfma_f32_32x32x16_bf16 v[64:79], v[48:51], a[8:11], v[64:79]
  ds_read_b64_tr_b16 v[32:33], v15 offset:6144
  ds_read_b64_tr_b16 v[34:35], v15 offset:7168
  buffer_load_dwordx4 a[76:79], v20, s[72:75], s56 offen offset:3072 sc1
  s_waitcnt lgkmcnt(4)
  v_mfma_f32_32x32x16_bf16 v[80:95], v[52:55], a[8:11], v[80:95]
  ds_read_b64_tr_b16 v[36:37], v14 offset:16384
  ds_read_b64_tr_b16 v[38:39], v14 offset:17408
  s_waitcnt vmcnt(16) lgkmcnt(4)
  v_mfma_f32_32x32x16_bf16 v[64:79], v[56:59], a[12:15], v[64:79]
  ds_read_b64_tr_b16 v[40:41], v15 offset:16384
  ds_read_b64_tr_b16 v[42:43], v15 offset:17408
  buffer_load_dwordx4 a[80:83], v20, s[72:75], s57 offen offset:0 sc1
  s_waitcnt lgkmcnt(4)
  v_mfma_f32_32x32x16_bf16 v[80:95], v[32:35], a[12:15], v[80:95]
  ds_read_b64_tr_b16 v[44:45], v14 offset:18432
  ds_read_b64_tr_b16 v[46:47], v14 offset:19456
  s_waitcnt vmcnt(16) lgkmcnt(4)
  v_mfma_f32_32x32x16_bf16 v[64:79], v[36:39], a[16:19], v[64:79]
  ds_read_b64_tr_b16 v[48:49], v15 offset:18432
  ds_read_b64_tr_b16 v[50:51], v15 offset:19456
  buffer_load_dwordx4 a[84:87], v20, s[72:75], s57 offen offset:1024 sc1
  s_waitcnt lgkmcnt(4)
  v_mfma_f32_32x32x16_bf16 v[80:95], v[40:43], a[16:19], v[80:95]
  ds_read_b64_tr_b16 v[52:53], v14 offset:20480
  ds_read_b64_tr_b16 v[54:55], v14 offset:21504
  s_waitcnt vmcnt(16) lgkmcnt(4)
  v_mfma_f32_32x32x16_bf16 v[64:79], v[44:47], a[20:23], v[64:79]
  ds_read_b64_tr_b16 v[56:57], v15 offset:20480
  ds_read_b64_tr_b16 v[58:59], v15 offset:21504
  buffer_load_dwordx4 a[88:91], v20, s[72:75], s57 offen offset:2048 sc1
  s_waitcnt lgkmcnt(4)
  v_mfma_f32_32x32x16_bf16 v[80:95], v[48:51], a[20:23], v[80:95]
  ds_read_b64_tr_b16 v[32:33], v14 offset:22528
  ds_read_b64_tr_b16 v[34:35], v14 offset:23552
  s_waitcnt vmcnt(16) lgkmcnt(4)
  v_mfma_f32_32x32x16_bf16 v[64:79], v[52:55], a[24:27], v[64:79]
  ds_read_b64_tr_b16 v[36:37], v15 offset:22528
  ds_read_b64_tr_b16 v[38:39], v15 offset:23552
  buffer_load_dwordx4 a[92:95], v20, s[72:75], s57 offen offset:3072 sc1
  s_waitcnt lgkmcnt(4)
  v_mfma_f32_32x32x16_bf16 v[80:95], v[56:59], a[24:27], v[80:95]
  ds_read_b64_tr_b16 v[40:41], v14 offset:32768
  ds_read_b64_tr_b16 v[42:43], v14 offset:33792
  s_waitcnt vmcnt(16) lgkmcnt(4)
  v_mfma_f32_32x32x16_bf16 v[64:79], v[32:35], a[28:31], v[64:79]
  ds_read_b64_tr_b16 v[44:45], v15 offset:32768
  ds_read_b64_tr_b16 v[46:47], v15 offset:33792
  buffer_load_dwordx4 a[96:99], v20, s[72:75], s58 offen offset:0 sc1
  s_waitcnt lgkmcnt(4)
  v_mfma_f32_32x32x16_bf16 v[80:95], v[36:39], a[28:31], v[80:95]
  ds_read_b64_tr_b16 v[48:49], v14 offset:34816
  ds_read_b64_tr_b16 v[50:51], v14 offset:35840
  s_waitcnt vmcnt(16) lgkmcnt(4)
  v_mfma_f32_32x32x16_bf16 v[64:79], v[40:43], a[32:35], v[64:79]
  ds_read_b64_tr_b16 v[52:53], v15 offset:34816
  ds_read_b64_tr_b16 v[54:55], v15 offset:35840
  buffer_load_dwordx4 a[100:103], v20, s[72:75], s58 offen offset:1024 sc1
  s_waitcnt lgkmcnt(4)
  v_mfma_f32_32x32x16_bf16 v[80:95], v[44:47], a[32:35], v[80:95]
  ds_read_b64_tr_b16 v[56:57], v14 offset:36864
  ds_read_b64_tr_b16 v[58:59], v14 offset:37888
  ds_read_b32 v28, v23 offset:0
  ds_read_b32 v29, v24 offset:0
  v_lshrrev_b32 v7, 2, v4
  v_and_b32 v8, 3, v4
  v_lshrrev_b32 v9, 4, v4
  v_xor_b32 v8, v8, v9
  s_waitcnt vmcnt(16) lgkmcnt(6)
  v_mfma_f32_32x32x16_bf16 v[64:79], v[48:51], a[36:39], v[64:79]
  ds_read_b64_tr_b16 v[32:33], v15 offset:36864
  ds_read_b64_tr_b16 v[34:35], v15 offset:37888
  buffer_load_dwordx4 a[104:107], v20, s[72:75], s58 offen offset:2048 sc1
  v_lshlrev_b32 v8, 4, v8
  v_lshl_add_u32 v60, v7, 10, v8
  v_add_u32 v61, 15360, v60
  s_lshl1_add_u32 s13, s69, s42
  s_lshl_b32 s45, s13, 8
  s_waitcnt lgkmcnt(6)
  v_mfma_f32_32x32x16_bf16 v[80:95], v[52:55], a[36:39], v[80:95]
  ds_read_b64_tr_b16 v[36:37], v14 offset:38912
  ds_read_b64_tr_b16 v[38:39], v14 offset:39936
  s_add_u32 s45, s45, 27262976
  s_lshl_b32 s13, s13, 15
  s_lshl1_add_u32 s14, s11, s43
  s_lshl_b32 s14, s14, 6
  s_mul_i32 s15, s6, 2304
  s_add_u32 s46, s15, 114688
  s_waitcnt vmcnt(16) lgkmcnt(6)
  v_mfma_f32_32x32x16_bf16 v[64:79], v[56:59], a[40:43], v[64:79]
  ds_read_b64_tr_b16 v[40:41], v15 offset:38912
  ds_read_b64_tr_b16 v[42:43], v15 offset:39936
  buffer_load_dwordx4 a[108:111], v20, s[72:75], s58 offen offset:3072 sc1
  s_waitcnt lgkmcnt(7)
  v_cmp_gt_u32 vcc, 20, v28
  s_cbranch_vccnz L_sp_118
L_sd_119:
  s_mov_b32 m0, s46
  s_add_u32 s99, s13, s14
  s_waitcnt lgkmcnt(6)
  v_cmp_gt_u32 vcc, 6, v29
  s_cbranch_vccnz L_sp_121
L_sd_122:
  s_waitcnt lgkmcnt(4)
  v_mfma_f32_32x32x16_bf16 v[80:95], v[32:35], a[40:43], v[80:95]
  ds_read_b64_tr_b16 v[44:45], v14 offset:49152
  ds_read_b64_tr_b16 v[46:47], v14 offset:50176
  s_waitcnt vmcnt(16) lgkmcnt(4)
  v_mfma_f32_32x32x16_bf16 v[64:79], v[36:39], a[44:47], v[64:79]
  ds_read_b64_tr_b16 v[48:49], v15 offset:49152
  ds_read_b64_tr_b16 v[50:51], v15 offset:50176
  v_and_b32 v1, 31, v4
  v_lshrrev_b32 v2, 5, v4
  v_bfe_u32 v8, v4, 2, 2
  v_lshlrev_b32 v8, 4, v8
  s_waitcnt lgkmcnt(4)
  v_mfma_f32_32x32x16_bf16 v[80:95], v[40:43], a[44:47], v[80:95]
  ds_read_b64_tr_b16 v[52:53], v14 offset:51200
  ds_read_b64_tr_b16 v[54:55], v14 offset:52224
  v_lshl_add_u32 v8, v2, 3, v8
  v_lshl_add_u32 v8, v1, 6, v8
  v_add_u32 v8, s46, v8
  v_xor_b32 v9, 16, v8
  s_waitcnt vmcnt(15) lgkmcnt(4)
  v_mfma_f32_32x32x16_bf16 v[64:79], v[44:47], a[48:51], v[64:79]
  ds_read_b64_tr_b16 v[56:57], v15 offset:51200
  ds_read_b64_tr_b16 v[58:59], v15 offset:52224
  v_xor_b32 v10, 32, v8
  v_xor_b32 v11, 48, v8
  v_and_b32 v1, 7, v4
  v_bfe_u32 v7, v4, 4, 1
  s_waitcnt lgkmcnt(4)
  v_mfma_f32_32x32x16_bf16 v[80:95], v[48:51], a[48:51], v[80:95]
  ds_read_b64_tr_b16 v[32:33], v14 offset:53248
  ds_read_b64_tr_b16 v[34:35], v14 offset:54272
  v_lshlrev_b32 v7, 2, v7
  v_xor_b32 v1, v1, v7
  v_and_b32 v7, 1, v1
  v_lshrrev_b32 v1, 1, v1
  s_waitcnt vmcnt(14) lgkmcnt(4)
  v_mfma_f32_32x32x16_bf16 v[64:79], v[52:55], a[52:55], v[64:79]
  ds_read_b64_tr_b16 v[36:37], v15 offset:53248
  ds_read_b64_tr_b16 v[38:39], v15 offset:54272
  v_lshl_add_u32 v1, v7, 2, v1
  v_lshrrev_b32 v7, 3, v4
  v_lshlrev_b32 v7, 12, v7
  v_lshl_add_u32 v13, v1, 4, v7
  s_waitcnt lgkmcnt(4)
  v_mfma_f32_32x32x16_bf16 v[80:95], v[56:59], a[52:55], v[80:95]
  ds_read_b64_tr_b16 v[40:41], v14 offset:55296
  ds_read_b64_tr_b16 v[42:43], v14 offset:56320
  v_add_u32 v12, 31744, v13
  v_and_b32 v18, 3, v4
  v_lshlrev_b32 v18, 3, v18
  v_bfe_u32 v1, v4, 2, 2
  s_waitcnt vmcnt(13) lgkmcnt(4)
  v_mfma_f32_32x32x16_bf16 v[64:79], v[32:35], a[56:59], v[64:79]
  ds_read_b64_tr_b16 v[44:45], v15 offset:55296
  ds_read_b64_tr_b16 v[46:47], v15 offset:56320
  v_lshl_add_u32 v18, v1, 7, v18
  v_bfe_u32 v1, v4, 3, 1
  v_xor_b32 v1, s42, v1
  v_lshl_add_u32 v18, v1, 6, v18
  s_waitcnt lgkmcnt(4)
  v_mfma_f32_32x32x16_bf16 v[80:95], v[36:39], a[56:59], v[80:95]
  ds_read_b64_tr_b16 v[48:49], v16 offset:32768
  ds_read_b64_tr_b16 v[50:51], v16 offset:33792
  v_bfe_u32 v1, v4, 4, 1
  v_lshl_add_u32 v18, v1, 5, v18
  v_lshl_add_u32 v18, v2, 9, v18
  s_lshl_b32 s13, s43, 12
  s_waitcnt vmcnt(12) lgkmcnt(4)
  v_mfma_f32_32x32x16_bf16 v[64:79], v[40:43], a[60:63], v[64:79]
  ds_read_b64_tr_b16 v[52:53], v17 offset:32768
  ds_read_b64_tr_b16 v[54:55], v17 offset:33792
  s_add_u32 s13, s13, 148480
  v_add_u32 v18, s13, v18
  v_and_b32 v21, 255, v6
  s_lshl2_add_u32 s13, s11, s6
  s_waitcnt lgkmcnt(4)
  v_mfma_f32_32x32x16_bf16 v[80:95], v[44:47], a[60:63], v[80:95]
  ds_read_b64_tr_b16 v[56:57], v16 offset:34816
  ds_read_b64_tr_b16 v[58:59], v16 offset:35840
  s_lshl_b32 s13, s13, 16
  s_lshl_b32 s14, s69, 7
  s_add_u32 s13, s13, s14
  s_add_u32 s47, s13, 25165824
  s_waitcnt vmcnt(11) lgkmcnt(4)
  v_mfma_f32_32x32x16_bf16 v[64:79], v[48:51], a[64:67], v[64:79]
  ds_read_b64_tr_b16 v[32:33], v17 offset:34816
  ds_read_b64_tr_b16 v[34:35], v17 offset:35840
  s_lshl_b32 s13, s6, 11
  s_add_u32 s61, s13, 148480
  v_add_u32 v7, s46, v5
  v_lshl_add_u32 v1, v4, 2, s46
  s_waitcnt lgkmcnt(4)
  v_mfma_f32_32x32x16_bf16 v[80:95], v[52:55], a[64:67], v[80:95]
  ds_read_b64_tr_b16 v[36:37], v16 offset:36864
  ds_read_b64_tr_b16 v[38:39], v16 offset:37888
  s_waitcnt vmcnt(10) lgkmcnt(4)
  v_mfma_f32_32x32x16_bf16 v[64:79], v[56:59], a[68:71], v[64:79]
  ds_read_b64_tr_b16 v[40:41], v17 offset:36864
  ds_read_b64_tr_b16 v[42:43], v17 offset:37888
  s_waitcnt lgkmcnt(4)
  v_mfma_f32_32x32x16_bf16 v[80:95], v[32:35], a[68:71], v[80:95]
  ds_read_b64_tr_b16 v[44:45], v16 offset:38912
  ds_read_b64_tr_b16 v[46:47], v16 offset:39936
  s_waitcnt vmcnt(9) lgkmcnt(4)
  v_mfma_f32_32x32x16_bf16 v[64:79], v[36:39], a[72:75], v[64:79]
  ds_read_b64_tr_b16 v[48:49], v17 offset:38912
  ds_read_b64_tr_b16 v[50:51], v17 offset:39936
  s_waitcnt lgkmcnt(4)
  v_mfma_f32_32x32x16_bf16 v[80:95], v[40:43], a[72:75], v[80:95]
  ds_read_b64_tr_b16 v[52:53], v16 offset:0
  ds_read_b64_tr_b16 v[54:55], v16 offset:1024
  s_waitcnt vmcnt(8) lgkmcnt(4)
  v_mfma_f32_32x32x16_bf16 v[64:79], v[44:47], a[76:79], v[64:79]
  ds_read_b64_tr_b16 v[56:57], v17 offset:0
  ds_read_b64_tr_b16 v[58:59], v17 offset:1024
  s_waitcnt lgkmcnt(4)
  v_mfma_f32_32x32x16_bf16 v[80:95], v[48:51], a[76:79], v[80:95]
  ds_read_b64_tr_b16 v[32:33], v16 offset:2048
  ds_read_b64_tr_b16 v[34:35], v16 offset:3072
  s_waitcnt vmcnt(7) lgkmcnt(4)
  v_mfma_f32_32x32x16_bf16 v[64:79], v[52:55], a[80:83], v[64:79]
  ds_read_b64_tr_b16 v[36:37], v17 offset:2048
  ds_read_b64_tr_b16 v[38:39], v17 offset:3072
  s_waitcnt lgkmcnt(4)
  v_mfma_f32_32x32x16_bf16 v[80:95], v[56:59], a[80:83], v[80:95]
  ds_read_b64_tr_b16 v[40:41], v16 offset:4096
  ds_read_b64_tr_b16 v[42:43], v16 offset:5120
  s_waitcnt vmcnt(6) lgkmcnt(4)
  v_mfma_f32_32x32x16_bf16 v[64:79], v[32:35], a[84:87], v[64:79]
  ds_read_b64_tr_b16 v[44:45], v17 offset:4096
  ds_read_b64_tr_b16 v[46:47], v17 offset:5120
  s_waitcnt lgkmcnt(4)
  v_mfma_f32_32x32x16_bf16 v[80:95], v[36:39], a[84:87], v[80:95]
  ds_read_b64_tr_b16 v[48:49], v16 offset:6144
  ds_read_b64_tr_b16 v[50:51], v16 offset:7168
  s_waitcnt vmcnt(5) lgkmcnt(4)
  v_mfma_f32_32x32x16_bf16 v[64:79], v[40:43], a[88:91], v[64:79]
  ds_read_b64_tr_b16 v[52:53], v17 offset:6144
  ds_read_b64_tr_b16 v[54:55], v17 offset:7168
  s_waitcnt lgkmcnt(4)
  v_mfma_f32_32x32x16_bf16 v[80:95], v[44:47], a[88:91], v[80:95]
  ds_read_b64_tr_b16 v[56:57], v17 offset:16384
  ds_read_b64_tr_b16 v[58:59], v17 offset:17408
  s_waitcnt vmcnt(4) lgkmcnt(4)
  v_mfma_f32_32x32x16_bf16 v[64:79], v[48:51], a[92:95], v[64:79]
  ds_read_b64_tr_b16 v[32:33], v17 offset:18432
  ds_read_b64_tr_b16 v[34:35], v17 offset:19456
  s_waitcnt lgkmcnt(4)
  v_mfma_f32_32x32x16_bf16 v[80:95], v[52:55], a[92:95], v[80:95]
  ds_read_b64_tr_b16 v[36:37], v17 offset:20480
  ds_read_b64_tr_b16 v[38:39], v17 offset:21504
  s_waitcnt vmcnt(3) lgkmcnt(4)
  v_mfma_f32_32x32x16_bf16 v[80:95], v[56:59], a[96:99], v[80:95]
  ds_read_b64_tr_b16 v[40:41], v17 offset:22528
  ds_read_b64_tr_b16 v[42:43], v17 offset:23552
  s_waitcnt vmcnt(2) lgkmcnt(4)
  v_mfma_f32_32x32x16_bf16 v[80:95], v[32:35], a[100:103], v[80:95]
  ds_read_b64_tr_b16 v[44:45], v16 offset:16384
  ds_read_b64_tr_b16 v[46:47], v16 offset:17408
  ds_read_b32 v29, v23 offset:0
  s_waitcnt vmcnt(1) lgkmcnt(5)
  v_mfma_f32_32x32x16_bf16 v[80:95], v[36:39], a[104:107], v[80:95]
  ds_read_b64_tr_b16 v[48:49], v16 offset:18432
  ds_read_b64_tr_b16 v[50:51], v16 offset:19456
  s_waitcnt vmcnt(0) lgkmcnt(5)
  v_mfma_f32_32x32x16_bf16 v[80:95], v[40:43], a[108:111], v[80:95]
  ds_read_b64_tr_b16 v[52:53], v16 offset:20480
  ds_read_b64_tr_b16 v[54:55], v16 offset:21504
  s_waitcnt lgkmcnt(5)
  v_mfma_f32_32x32x16_bf16 v[64:79], v[44:47], a[96:99], v[64:79]
  ds_read_b64_tr_b16 v[56:57], v16 offset:22528
  ds_read_b64_tr_b16 v[58:59], v16 offset:23552
  s_waitcnt lgkmcnt(6)
  v_cmp_gt_u32 vcc, 21, v29
  s_cbranch_vccnz L_sp_124
L_sd_125:
  s_waitcnt lgkmcnt(4)
  v_mfma_f32_32x32x16_bf16 v[64:79], v[48:51], a[100:103], v[64:79]
  ds_write_b128 v22, v[80:83] offset:0
  ds_write_b128 v22, v[84:87] offset:1024
  ds_write_b128 v22, v[88:91] offset:2048
  ds_write_b128 v22, v[92:95] offset:3072
  ds_write_b32 v25, v26
  v_add_u32 v26, 1, v26
  s_waitcnt lgkmcnt(7)
  v_mfma_f32_32x32x16_bf16 v[64:79], v[52:55], a[104:107], v[64:79]
  s_add_u32 s60, s62, 4096
  s_waitcnt lgkmcnt(5)
  v_mfma_f32_32x32x16_bf16 v[64:79], v[56:59], a[108:111], v[64:79]
  ds_read_b32 v28, v24 offset:0
  s_setprio 2
  s_waitcnt lgkmcnt(0)
  v_cmp_gt_u32 vcc, 8, v28
  s_cbranch_vccnz L_sp_127
L_sd_128:
  ds_read_b128 v[92:95], v19 offset:3072
  ds_read_b128 v[80:83], v19 offset:0
  ds_read_b128 v[84:87], v19 offset:1024
  ds_read_b128 v[88:91], v19 offset:2048
  ds_write_b32 v25, v26
  v_add_u32 v26, 1, v26
  s_waitcnt lgkmcnt(4)
  v_add_f32 v108, v76, v92
  v_add_f32 v109, v77, v93
  v_add_f32 v110, v78, v94
  v_add_f32 v111, v79, v95
  buffer_store_dwordx4 v[108:111], v5, s[72:75], s62 offen offset:3072 sc1
  s_waitcnt lgkmcnt(3)
  v_add_f32 v96, v64, v80
  v_add_f32 v97, v65, v81
  v_add_f32 v98, v66, v82
  v_add_f32 v99, v67, v83
  buffer_store_dwordx4 v[96:99], v5, s[72:75], s62 offen offset:0 sc1
  s_waitcnt lgkmcnt(0)
  s_load_dwordx16 s[80:95], s[72:73], s76 glc
  v_add_f32 v100, v68, v84
  v_add_f32 v101, v69, v85
  v_add_f32 v102, v70, v86
  v_add_f32 v103, v71, v87
  buffer_store_dwordx4 v[100:103], v5, s[72:75], s62 offen offset:1024 sc1
  v_add_f32 v104, v72, v88
  v_add_f32 v105, v73, v89
  v_add_f32 v106, v74, v90
  v_add_f32 v107, v75, v91
  buffer_store_dwordx4 v[104:107], v5, s[72:75], s62 offen offset:2048 sc1
  buffer_load_dwordx4 v60, s[48:51], s99 offen lds
  buffer_load_dwordx4 v61, s[48:51], s99 offen offset:1024 lds
  s_mov_b32 m0, s61
  s_waitcnt lgkmcnt(0)
  s_xor_b64 s[66:67], s[80:81], s[64:65]
  s_xor_b64 s[82:83], s[82:83], s[64:65]
  s_or_b64 s[66:67], s[66:67], s[82:83]
  s_xor_b64 s[84:85], s[84:85], s[64:65]
  s_or_b64 s[66:67], s[66:67], s[84:85]
  s_xor_b64 s[86:87], s[86:87], s[64:65]
  s_or_b64 s[66:67], s[66:67], s[86:87]
  s_xor_b64 s[88:89], s[88:89], s[64:65]
  s_or_b64 s[66:67], s[66:67], s[88:89]
  s_xor_b64 s[90:91], s[90:91], s[64:65]
  s_or_b64 s[66:67], s[66:67], s[90:91]
  s_xor_b64 s[92:93], s[92:93], s[64:65]
  s_or_b64 s[66:67], s[66:67], s[92:93]
  s_xor_b64 s[94:95], s[94:95], s[64:65]
  s_or_b64 s[66:67], s[66:67], s[94:95]
  s_cbranch_scc0 L_yd
  s_mov_b32 s68, 0
  s_mov_b32 s15, 0
L_yp:
  s_load_dwordx16 s[80:95], s[72:73], s76 glc
L_yw:
  s_getreg_b32 s13, hwreg(HW_REG_IB_STS)
  s_and_b32 s13, s13, 0xc0000f
  s_cmp_le_u32 s13, 2
  s_cbranch_scc0 L_yt
  s_cmp_lg_u32 s15, 0
  s_cbranch_scc1 L_yt
  buffer_store_dwordx2 v[30:31], v3, s[72:75], s63 offen sc1
  s_mov_b32 s15, 1
L_yt:
  s_getreg_b32 s13, hwreg(HW_REG_IB_STS, 8, 4)
  s_cmp_lg_u32 s13, 0
  s_cbranch_scc1 L_yw
  s_add_u32 s68, s68, 1
  s_cmp_gt_u32 s68, 0x20000
  s_cbranch_scc1 L_yd
  s_xor_b64 s[66:67], s[80:81], s[64:65]
  s_xor_b64 s[82:83], s[82:83], s[64:65]
  s_or_b64 s[66:67], s[66:67], s[82:83]
  s_xor_b64 s[84:85], s[84:85], s[64:65]
  s_or_b64 s[66:67], s[66:67], s[84:85]
  s_xor_b64 s[86:87], s[86:87], s[64:65]
  s_or_b64 s[66:67], s[66:67], s[86:87]
  s_xor_b64 s[88:89], s[88:89], s[64:65]
  s_or_b64 s[66:67], s[66:67], s[88:89]
  s_xor_b64 s[90:91], s[90:91], s[64:65]
  s_or_b64 s[66:67], s[66:67], s[90:91]
  s_xor_b64 s[92:93], s[92:93], s[64:65]
  s_or_b64 s[66:67], s[66:67], s[92:93]
  s_xor_b64 s[94:95], s[94:95], s[64:65]
  s_or_b64 s[66:67], s[66:67], s[94:95]
  s_cbranch_scc1 L_yp
L_yd:
  buffer_load_dwordx4 v13, s[72:75], s47 offen sc1 lds
  buffer_load_dwordx4 v12, s[72:75], s47 offen offset:1024 sc1 lds
  buffer_load_dwordx2 v[32:33], v21, s[72:75], s45 offen sc1
  s_waitcnt vmcnt(5)
  buffer_store_dwordx2 v[30:31], v3, s[72:75], s63 offen offset:0 sc1
  s_waitcnt vmcnt(4)
  ds_read_b64 v[120:121], v8
  ds_read_b64 v[122:123], v9
  ds_read_b64 v[124:125], v10
  ds_read_b64 v[126:127], v11
  s_waitcnt lgkmcnt(0)
  v_lshlrev_b32 v40, 16, v120
  v_and_b32 v41, s32, v120
  v_lshlrev_b32 v42, 16, v121
  v_and_b32 v43, s32, v121
  v_lshlrev_b32 v44, 16, v122
  v_and_b32 v45, s32, v122
  v_lshlrev_b32 v46, 16, v123
  v_and_b32 v47, s32, v123
  v_lshlrev_b32 v48, 16, v124
  v_and_b32 v49, s32, v124
  v_lshlrev_b32 v50, 16, v125
  v_and_b32 v51, s32, v125
  v_lshlrev_b32 v52, 16, v126
  v_and_b32 v53, s32, v126
  v_lshlrev_b32 v54, 16, v127
  v_and_b32 v55, s32, v127
  s_waitcnt vmcnt(2)
  ds_write_b32 v25, v26
  v_add_u32 v26, 1, v26
  ds_read_b32 v28, v24 offset:0
  s_waitcnt vmcnt(1)
  v_cmp_ne_u32 vcc, s64, v33
  s_cbranch_vccnz L_gp_130
L_gd_131:
  v_lshlrev_b32 v34, 16, v32
  v_lshlrev_b32 v35, 16, v32
  v_and_b32 v36, s32, v32
  ds_write_b32 v1, v36 offset:2048
  s_waitcnt lgkmcnt(1)
  v_cmp_gt_u32 vcc, 10, v28
  s_cbranch_vccnz L_sp_133
L_sd_134:
  ds_read_b64_tr_b16 v[56:57], v18 offset:0
  ds_read_b64_tr_b16 v[58:59], v18 offset:1024
  ds_read_b64_tr_b16 v[60:61], v18 offset:2048
  ds_read_b64_tr_b16 v[62:63], v18 offset:3072
  s_waitcnt lgkmcnt(3)
  v_lshlrev_b32 v64, 16, v56
  v_and_b32 v65, s32, v56
  v_lshlrev_b32 v66, 16, v57
  v_and_b32 v67, s32, v57
  v_mul_f32 v40, v40, v64
  v_mul_f32 v41, v41, v65
  v_mul_f32 v42, v42, v66
  v_mul_f32 v43, v43, v67
  v_cvt_pk_bf16_f32 v40, 0, v40
  v_cvt_pk_bf16_f32 v41, 0, v41
  v_cvt_pk_bf16_f32 v42, 0, v42
  v_cvt_pk_bf16_f32 v43, 0, v43
  v_mul_f32 v40, v40, v34
  v_mul_f32 v41, v41, v35
  v_mul_f32 v42, v42, v34
  v_mul_f32 v43, v43, v35
  v_cvt_pk_bf16_f32 v72, v40, v41
  v_cvt_pk_bf16_f32 v73, v42, v43
  s_waitcnt lgkmcnt(2)
  v_lshlrev_b32 v64, 16, v58
  v_and_b32 v65, s32, v58
  v_lshlrev_b32 v66, 16, v59
  v_and_b32 v67, s32, v59
  v_mul_f32 v44, v44, v64
  v_mul_f32 v45, v45, v65
  v_mul_f32 v46, v46, v66
  v_mul_f32 v47, v47, v67
  v_cvt_pk_bf16_f32 v44, 0, v44
  v_cvt_pk_bf16_f32 v45, 0, v45
  v_cvt_pk_bf16_f32 v46, 0, v46
  v_cvt_pk_bf16_f32 v47, 0, v47
  v_mul_f32 v44, v44, v34
  v_mul_f32 v45, v45, v35
  v_mul_f32 v46, v46, v34
  v_mul_f32 v47, v47, v35
  v_cvt_pk_bf16_f32 v74, v44, v45
  v_cvt_pk_bf16_f32 v75, v46, v47
  ds_write_b128 v7, v[72:75] offset:0
  s_waitcnt lgkmcnt(2)
  v_lshlrev_b32 v64, 16, v60
  v_and_b32 v65, s32, v60
  v_lshlrev_b32 v66, 16, v61
  v_and_b32 v67, s32, v61
  v_mul_f32 v48, v48, v64
  v_mul_f32 v49, v49, v65
  v_mul_f32 v50, v50, v66
  v_mul_f32 v51, v51, v67
  v_cvt_pk_bf16_f32 v48, 0, v48
  v_cvt_pk_bf16_f32 v49, 0, v49
  v_cvt_pk_bf16_f32 v50, 0, v50
  v_cvt_pk_bf16_f32 v51, 0, v51
  v_mul_f32 v48, v48, v34
  v_mul_f32 v49, v49, v35
  v_mul_f32 v50, v50, v34
  v_mul_f32 v51, v51, v35
  v_cvt_pk_bf16_f32 v76, v48, v49
  v_cvt_pk_bf16_f32 v77, v50, v51
  s_waitcnt lgkmcnt(1)
  v_lshlrev_b32 v64, 16, v62
  v_and_b32 v65, s32, v62
  v_lshlrev_b32 v66, 16, v63
  v_and_b32 v67, s32, v63
  v_mul_f32 v52, v52, v64
  v_mul_f32 v53, v53, v65
  v_mul_f32 v54, v54, v66
  v_mul_f32 v55, v55, v67
  v_cvt_pk_bf16_f32 v52, 0, v52
  v_cvt_pk_bf16_f32 v53, 0, v53
  v_cvt_pk_bf16_f32 v54, 0, v54
  v_cvt_pk_bf16_f32 v55, 0, v55
  v_mul_f32 v52, v52, v34
  v_mul_f32 v53, v53, v35
  v_mul_f32 v54, v54, v34
  v_mul_f32 v55, v55, v35
  v_cvt_pk_bf16_f32 v78, v52, v53
  v_cvt_pk_bf16_f32 v79, v54, v55
  ds_write_b128 v7, v[76:79] offset:1024
  v_mov_b32 v26, 64
  ds_write_b32 v25, v26 offset:16
  s_waitcnt lgkmcnt(0)
  s_endpgm
L_free2:
  s_mov_b32 s56, s32
  s_mov_b32 s57, s33
  s_mov_b32 s58, 1835008
  s_mov_b32 s59, 0x00020000
  s_mov_b32 exec_lo, 65535
  s_mov_b32 exec_hi, 0
  s_add_u32 s14, s13, 917504
  buffer_load_dword v39, v37, s[52:55], s14 offen
  s_mov_b32 exec_lo, 65535
  s_mov_b32 exec_hi, 0
  buffer_load_dword v40, v36, s[48:51], s85 offen offset:512
  s_waitcnt vmcnt(5)
  s_mov_b32 exec_lo, 65535
  s_mov_b32 exec_hi, 0
  s_add_u32 s14, s13, 1146880
  buffer_load_dword v39, v37, s[52:55], s14 offen
  s_waitcnt vmcnt(5)
  s_mov_b32 exec_lo, 65535
  s_mov_b32 exec_hi, 0
  buffer_load_dword v40, v36, s[48:51], s85 offen offset:640
  s_waitcnt vmcnt(5)
  s_mov_b32 exec_lo, 65535
  s_mov_b32 exec_hi, 0
  s_add_u32 s14, s13, 1376256
  buffer_load_dword v39, v37, s[52:55], s14 offen
  s_waitcnt vmcnt(5)
  s_mov_b32 exec_lo, 65535
  s_mov_b32 exec_hi, 0
  buffer_load_dword v40, v36, s[48:51], s85 offen offset:768
  s_waitcnt vmcnt(5)
  s_mov_b32 exec_lo, 65535
  s_mov_b32 exec_hi, 0
  s_add_u32 s14, s13, 1605632
  buffer_load_dword v39, v37, s[52:55], s14 offen
  s_waitcnt vmcnt(5)
  s_mov_b32 exec_lo, 65535
  s_mov_b32 exec_hi, 0
  buffer_load_dword v40, v36, s[48:51], s85 offen offset:896
  s_waitcnt vmcnt(5)
  s_mov_b32 exec_lo, 268435455
  s_mov_b32 exec_hi, 0
  buffer_load_dword v39, v38, s[56:59], s15 offen
  s_add_u32 s15, s15, 3584
  s_waitcnt vmcnt(5)
  s_mov_b32 exec_lo, 268435455
  s_mov_b32 exec_hi, 0
  buffer_load_dword v39, v38, s[56:59], s15 offen
  s_add_u32 s15, s15, 3584
  s_waitcnt vmcnt(5)
  s_mov_b32 exec_lo, 268435455
  s_mov_b32 exec_hi, 0
  buffer_load_dword v39, v38, s[56:59], s15 offen
  s_add_u32 s15, s15, 3584
  s_waitcnt vmcnt(5)
  s_mov_b32 exec_lo, 268435455
  s_mov_b32 exec_hi, 0
  buffer_load_dword v39, v38, s[56:59], s15 offen
  s_add_u32 s15, s15, 3584
  s_mov_b64 exec, -1
L_fpdone:
  s_add_u32 s72, s40, 234881024
  s_addc_u32 s73, s41, 0
  s_mov_b32 s74, 33554432
  s_mov_b32 s75, 0x00020000
  s_mov_b32 s56, s32
  s_mov_b32 s57, s33
  s_mov_b32 s58, 1835008
  s_mov_b32 s59, 0x00020000
  s_mov_b32 s60, s36
  s_mov_b32 s61, s37
  s_mov_b32 s62, 2097152
  s_mov_b32 s63, 0x00020000
  v_lshlrev_b32 v32, 4, v2
  v_lshl_add_u32 v13, v1, 10, v32
  v_add_u32 v14, 7168, v13
  v_add_u32 v15, 14336, v13
  v_add_u32 v16, 21504, v13
  s_mul_i32 s13, s12, 0
  s_add_u32 s13, s13, s11
  s_cmp_ge_u32 s13, 7
  s_cselect_b32 s14, 7, 0
  s_sub_u32 s13, s13, s14
  s_cmp_ge_u32 s13, 7
  s_cselect_b32 s14, 7, 0
  s_sub_u32 s78, s13, s14
  s_add_u32 s13, s78, 1
  s_cmp_ge_u32 s13, 7
  s_cselect_b32 s14, 7, 0
  s_sub_u32 s79, s13, s14
  s_add_u32 s13, s79, 1
  s_cmp_ge_u32 s13, 7
  s_cselect_b32 s14, 7, 0
  s_sub_u32 s80, s13, s14
  s_add_u32 s13, s80, 1
  s_cmp_ge_u32 s13, 7
  s_cselect_b32 s14, 7, 0
  s_sub_u32 s81, s13, s14
  s_add_u32 s13, s81, 1
  s_cmp_ge_u32 s13, 7
  s_cselect_b32 s14, 7, 0
  s_sub_u32 s82, s13, s14
  s_add_u32 s13, s82, 1
  s_cmp_ge_u32 s13, 7
  s_cselect_b32 s14, 7, 0
  s_sub_u32 s83, s13, s14
  s_add_u32 s13, s83, 1
  s_cmp_ge_u32 s13, 7
  s_cselect_b32 s14, 7, 0
  s_sub_u32 s84, s13, s14
  s_mul_i32 s13, s10, 917504
  s_lshl_b32 s14, s6, 15
  s_add_u32 s13, s13, s14
  s_lshl_b32 s14, s11, 7
  s_add_u32 s87, s13, s14
  s_mul_i32 s13, s69, 229376
  s_add_u32 s13, s13, 4194304
  s_lshl2_add_u32 s14, s11, s6
  s_lshl_b32 s14, s14, 11
  s_add_u32 s90, s13, s14
  s_mul_i32 s14, s42, 57344
  s_add_u32 s13, s13, s14
  s_lshl_b32 s14, s43, 12
  s_add_u32 s91, s13, s14
  s_lshl_b32 s13, s69, 15
  s_lshl_b32 s14, s43, 11
  s_add_u32 s13, s13, s14
  s_add_u32 s13, s13, 30408704
  s_lshl_b32 s14, s11, 12
  s_add_u32 s93, s13, s14
  s_lshl1_add_u32 s14, s11, s42
  s_lshl2_add_u32 s92, s14, s13
  v_cmp_gt_u32 vcc, 8, v4
  v_lshlrev_b32 v23, 12, v4
  v_mov_b32 v33, 2.0
  v_cndmask_b32 v34, v33, v23, vcc
  s_lshl_b32 s13, s7, 5
  s_add_u32 s13, s13, s8
  s_lshl_b32 s14, s13, 2
  s_load_dword s94, s[26:27], s14
  s_lshl2_add_u32 s13, s2, s6
  s_lshl_b32 s15, s13, 13
  s_add_u32 s96, s15, 12582912
  s_lshl_b32 s15, s13, 6
  s_add_u32 s97, s15, 28508160
  s_lshl1_add_u32 s13, s69, s42
  s_lshl_b32 s13, s13, 15
  s_lshl1_add_u32 s14, s11, s43
  s_lshl_b32 s14, s14, 6
  s_add_u32 s98, s13, s14
  v_and_b32 v32, 3, v4
  v_lshlrev_b32 v32, 2, v32
  v_add_u32 v24, 163584, v32
  s_lshl_b32 s13, s6, 2
  s_add_u32 s13, s13, 163584
  v_mov_b32 v25, s13
  v_and_b32 v1, 31, v4
  v_lshrrev_b32 v2, 5, v4
  v_bfe_u32 v32, v4, 1, 3
  v_xor_b32 v32, v2, v32
  v_lshlrev_b32 v32, 4, v32
  v_lshl_add_u32 v32, v1, 7, v32
  v_add_u32 v17, 65536, v32
  v_xor_b32 v18, 32, v17
  v_xor_b32 v19, 64, v17
  v_xor_b32 v20, 96, v17
  v_bfe_u32 v1, v4, 2, 2
  v_and_b32 v32, 3, v4
  v_lshlrev_b32 v32, 3, v32
  v_lshl_add_u32 v32, v1, 7, v32
  v_bfe_u32 v1, v4, 3, 1
  v_lshl_add_u32 v32, v1, 6, v32
  v_bfe_u32 v1, v4, 4, 1
  v_lshl_add_u32 v32, v1, 5, v32
  v_lshl_add_u32 v21, v2, 10, v32
  s_lshl_b32 s13, s42, 6
  s_lshl_b32 s14, s43, 13
  v_xor_b32 v21, s13, v21
  v_add_u32 v21, s14, v21
  v_lshl_add_u32 v22, v2, 9, v32
  s_lshl_b32 s13, s43, 6
  v_xor_b32 v22, s13, v22
  v_add_u32 v22, s14, v22
  v_mov_b32 v32, 0xbfb8aa3b
  s_mov_b32 s0, 0xffff0000
  v_mov_b32 v33, 1.0
  s_add_u32 s14, s88, 123904
  v_add_u32 v1, s14, v5
  s_cmp_eq_u32 s11, 7
  s_cbranch_scc1 L_FREE
  s_add_u32 m0, s88, 16384
  s_add_u32 s4, s86, 229376
  buffer_load_dwordx4 v7, s[52:55], s4 offen offset:0 lds
  buffer_load_dwordx4 v8, s[52:55], s4 offen offset:1024 lds
  buffer_load_dwordx4 v9, s[52:55], s4 offen offset:2048 lds
  s_waitcnt vmcnt(8)
  buffer_load_dwordx4 v10, s[52:55], s4 offen offset:3072 lds
  s_waitcnt vmcnt(8)
  s_add_u32 m0, s89, 73728
  s_add_u32 s4, s85, 128
  buffer_load_dwordx4 v11, s[48:51], s4 offen offset:0 lds
  s_waitcnt vmcnt(8)
  buffer_load_dwordx4 v12, s[48:51], s4 offen offset:1024 lds
  s_waitcnt vmcnt(8)
  s_add_u32 m0, s88, 32768
  s_add_u32 s4, s86, 458752
  buffer_load_dwordx4 v7, s[52:55], s4 offen offset:0 lds
  s_waitcnt vmcnt(8)
  buffer_load_dwordx4 v8, s[52:55], s4 offen offset:1024 lds
  s_waitcnt vmcnt(8)
  buffer_load_dwordx4 v9, s[52:55], s4 offen offset:2048 lds
  s_waitcnt vmcnt(8)
  buffer_load_dwordx4 v10, s[52:55], s4 offen offset:3072 lds
  s_waitcnt vmcnt(8)
  s_add_u32 m0, s89, 81920
  s_add_u32 s4, s85, 256
  buffer_load_dwordx4 v11, s[48:51], s4 offen offset:0 lds
  s_waitcnt vmcnt(8)
  buffer_load_dwordx4 v12, s[48:51], s4 offen offset:1024 lds
  s_waitcnt vmcnt(8)
  s_add_u32 m0, s88, 49152
  s_add_u32 s4, s86, 688128
  buffer_load_dwordx4 v7, s[52:55], s4 offen offset:0 lds
  s_waitcnt vmcnt(8)
  buffer_load_dwordx4 v8, s[52:55], s4 offen offset:1024 lds
  s_waitcnt vmcnt(8)
  buffer_load_dwordx4 v9, s[52:55], s4 offen offset:2048 lds
  s_waitcnt vmcnt(8)
  buffer_load_dwordx4 v10, s[52:55], s4 offen offset:3072 lds
  s_waitcnt vmcnt(8)
  s_add_u32 m0, s89, 90112
  s_add_u32 s4, s85, 384
  buffer_load_dwordx4 v11, s[48:51], s4 offen offset:0 lds
  s_waitcnt vmcnt(8)
  buffer_load_dwordx4 v12, s[48:51], s4 offen offset:1024 lds
  s_waitcnt vmcnt(8)
  s_add_u32 m0, s89, 98304
  s_add_u32 s4, s85, 512
  buffer_load_dwordx4 v11, s[48:51], s4 offen offset:0 lds
  s_waitcnt vmcnt(8)
  buffer_load_dwordx4 v12, s[48:51], s4 offen offset:1024 lds
  s_waitcnt vmcnt(8)
  s_add_u32 m0, s89, 106496
  s_add_u32 s4, s85, 640
  buffer_load_dwordx4 v11, s[48:51], s4 offen offset:0 lds
  s_waitcnt vmcnt(8)
  buffer_load_dwordx4 v12, s[48:51], s4 offen offset:1024 lds
  ds_write_b32 v25, v26
  v_add_u32 v26, 1, v26
  ds_read_b32 v28, v24 offset:0
  s_waitcnt lgkmcnt(0)
  v_cmp_gt_u32 vcc, 1, v28
  s_cbranch_vccnz L_sp_59
L_sd_60:
  ds_read_b64_tr_b16 a[0:1], v21 offset:0
  ds_read_b64_tr_b16 a[2:3], v21 offset:512
  ds_read_b128 v[44:47], v17 offset:0
  ds_read_b64_tr_b16 a[4:5], v21 offset:2048
  ds_read_b64_tr_b16 a[6:7], v21 offset:2560
  ds_read_b128 v[48:51], v17 offset:4096
  ds_read_b64_tr_b16 a[8:9], v21 offset:4096
  ds_read_b64_tr_b16 a[10:11], v21 offset:4608
  ds_read_b128 v[52:55], v18 offset:0
  ds_read_b64_tr_b16 a[12:13], v21 offset:6144
  ds_read_b64_tr_b16 a[14:15], v21 offset:6656
  s_waitcnt lgkmcnt(8)
  v_mfma_f32_32x32x16_bf16 v[64:79], a[0:3], v[44:47], 0
  ds_read_b128 v[56:59], v18 offset:4096
  ds_write_b32 v25, v26
  v_add_u32 v26, 1, v26
  s_waitcnt lgkmcnt(7)
  v_mfma_f32_32x32x16_bf16 v[80:95], a[0:3], v[48:51], 0
  ds_read_b128 v[60:63], v19 offset:0
  s_waitcnt lgkmcnt(5)
  v_mfma_f32_32x32x16_bf16 v[64:79], a[4:7], v[52:55], v[64:79]
  ds_read_b128 v[96:99], v19 offset:4096
  s_waitcnt lgkmcnt(3)
  v_mfma_f32_32x32x16_bf16 v[80:95], a[4:7], v[56:59], v[80:95]
  ds_read_b128 v[100:103], v20 offset:0
  ds_read_b32 v28, v24 offset:0
  s_waitcnt lgkmcnt(3)
  v_mfma_f32_32x32x16_bf16 v[64:79], a[8:11], v[60:63], v[64:79]
  ds_read_b128 v[104:107], v20 offset:4096
  s_waitcnt lgkmcnt(1)
  v_cmp_gt_u32 vcc, 2, v28
  v_mfma_f32_32x32x16_bf16 v[80:95], a[8:11], v[96:99], v[80:95]
  s_cbranch_vccnz L_sp_1
L_sd_2:
  ds_read_b128 v[108:111], v17 offset:8192
  ds_read_b64_tr_b16 a[16:17], v21 offset:16384
  ds_read_b64_tr_b16 a[18:19], v21 offset:16896
  s_add_u32 m0, s88, 0
  s_add_u32 s4, s86, 917504
  buffer_load_dwordx4 v7, s[52:55], s4 offen offset:0 lds
  v_mfma_f32_32x32x16_bf16 v[64:79], a[12:15], v[100:103], v[64:79]
  ds_read_b128 v[44:47], v17 offset:12288
  ds_read_b64_tr_b16 a[20:21], v21 offset:18432
  ds_read_b64_tr_b16 a[22:23], v21 offset:18944
  ds_read_b64_tr_b16 a[24:25], v21 offset:20480
  ds_read_b64_tr_b16 a[26:27], v21 offset:20992
  s_waitcnt lgkmcnt(8)
  v_mfma_f32_32x32x16_bf16 v[80:95], a[12:15], v[104:107], v[80:95]
  ds_read_b128 v[48:51], v18 offset:8192
  ds_read_b64_tr_b16 a[28:29], v21 offset:22528
  ds_read_b64_tr_b16 a[30:31], v21 offset:23040
  ds_write_b32 v25, v26
  buffer_load_dwordx4 v8, s[52:55], s4 offen offset:1024 lds
  v_add_u32 v26, 1, v26
  s_waitcnt lgkmcnt(9)
  v_mfma_f32_32x32x16_bf16 v[64:79], a[16:19], v[108:111], v[64:79]
  ds_read_b128 v[52:55], v18 offset:12288
  s_waitcnt lgkmcnt(9)
  v_mfma_f32_32x32x16_bf16 v[80:95], a[16:19], v[44:47], v[80:95]
  ds_read_b128 v[56:59], v19 offset:8192
  buffer_load_dwordx4 v9, s[52:55], s4 offen offset:2048 lds
  s_waitcnt lgkmcnt(5)
  v_mfma_f32_32x32x16_bf16 v[64:79], a[20:23], v[48:51], v[64:79]
  ds_read_b128 v[60:63], v19 offset:12288
  s_waitcnt lgkmcnt(2)
  v_mfma_f32_32x32x16_bf16 v[80:95], a[20:23], v[52:55], v[80:95]
  ds_read_b128 v[96:99], v20 offset:8192
  ds_read_b32 v28, v24 offset:0
  buffer_load_dwordx4 v10, s[52:55], s4 offen offset:3072 lds
  s_waitcnt lgkmcnt(3)
  v_mfma_f32_32x32x16_bf16 v[64:79], a[24:27], v[56:59], v[64:79]
  ds_read_b128 v[100:103], v20 offset:12288
  s_waitcnt lgkmcnt(1)
  v_cmp_gt_u32 vcc, 3, v28
  v_mfma_f32_32x32x16_bf16 v[80:95], a[24:27], v[60:63], v[80:95]
  s_cbranch_vccnz L_sp_4
L_sd_5:
  ds_read_b128 v[104:107], v17 offset:16384
  ds_read_b64_tr_b16 a[32:33], v21 offset:32768
  ds_read_b64_tr_b16 a[34:35], v21 offset:33280
  s_add_u32 m0, s88, 16384
  s_add_u32 s4, s86, 1146880
  buffer_load_dwordx4 v7, s[52:55], s4 offen offset:0 lds
  v_mfma_f32_32x32x16_bf16 v[64:79], a[28:31], v[96:99], v[64:79]
  ds_read_b128 v[108:111], v17 offset:20480
  ds_read_b64_tr_b16 a[36:37], v21 offset:34816
  ds_read_b64_tr_b16 a[38:39], v21 offset:35328
  ds_read_b64_tr_b16 a[40:41], v21 offset:36864
  ds_read_b64_tr_b16 a[42:43], v21 offset:37376
  buffer_load_dwordx4 v8, s[52:55], s4 offen offset:1024 lds
  s_waitcnt vmcnt(10) lgkmcnt(8)
  v_mfma_f32_32x32x16_bf16 v[80:95], a[28:31], v[100:103], v[80:95]
  ds_read_b128 v[44:47], v18 offset:16384
  ds_read_b64_tr_b16 a[44:45], v21 offset:38912
  ds_read_b64_tr_b16 a[46:47], v21 offset:39424
  ds_write_b32 v25, v26
  buffer_load_dwordx4 v9, s[52:55], s4 offen offset:2048 lds
  v_add_u32 v26, 1, v26
  s_waitcnt lgkmcnt(9)
  v_mfma_f32_32x32x16_bf16 v[64:79], a[32:35], v[104:107], v[64:79]
  ds_read_b128 v[48:51], v18 offset:20480
  s_waitcnt lgkmcnt(9)
  v_mfma_f32_32x32x16_bf16 v[80:95], a[32:35], v[108:111], v[80:95]
  ds_read_b128 v[52:55], v19 offset:16384
  buffer_load_dwordx4 v10, s[52:55], s4 offen offset:3072 lds
  s_waitcnt lgkmcnt(5)
  v_mfma_f32_32x32x16_bf16 v[64:79], a[36:39], v[44:47], v[64:79]
  ds_read_b128 v[56:59], v19 offset:20480
  s_add_u32 m0, s89, 65536
  s_add_u32 s4, s85, 768
  buffer_load_dwordx4 v11, s[48:51], s4 offen offset:0 lds
  s_waitcnt lgkmcnt(2)
  v_mfma_f32_32x32x16_bf16 v[80:95], a[36:39], v[48:51], v[80:95]
  ds_read_b128 v[60:63], v20 offset:16384
  ds_read_b32 v28, v24 offset:0
  buffer_load_dwordx4 v12, s[48:51], s4 offen offset:1024 lds
  s_waitcnt lgkmcnt(3)
  v_mfma_f32_32x32x16_bf16 v[64:79], a[40:43], v[52:55], v[64:79]
  ds_read_b128 v[96:99], v20 offset:20480
  s_waitcnt lgkmcnt(1)
  v_cmp_gt_u32 vcc, 4, v28
  v_mfma_f32_32x32x16_bf16 v[80:95], a[40:43], v[56:59], v[80:95]
  s_cbranch_vccnz L_sp_7
L_sd_8:
  ds_read_b128 v[100:103], v17 offset:24576
  ds_read_b64_tr_b16 a[48:49], v21 offset:49152
  ds_read_b64_tr_b16 a[50:51], v21 offset:49664
  s_add_u32 m0, s88, 32768
  s_add_u32 s4, s86, 1376256
  buffer_load_dwordx4 v7, s[52:55], s4 offen offset:0 lds
  v_mfma_f32_32x32x16_bf16 v[64:79], a[44:47], v[60:63], v[64:79]
  ds_read_b128 v[104:107], v17 offset:28672
  ds_read_b64_tr_b16 a[52:53], v21 offset:51200
  ds_read_b64_tr_b16 a[54:55], v21 offset:51712
  ds_read_b64_tr_b16 a[56:57], v21 offset:53248
  ds_read_b64_tr_b16 a[58:59], v21 offset:53760
  buffer_load_dwordx4 v8, s[52:55], s4 offen offset:1024 lds
  s_waitcnt vmcnt(8) lgkmcnt(8)
  v_mfma_f32_32x32x16_bf16 v[80:95], a[44:47], v[96:99], v[80:95]
  ds_read_b128 v[108:111], v18 offset:24576
  ds_read_b64_tr_b16 a[60:61], v21 offset:55296
  ds_read_b64_tr_b16 a[62:63], v21 offset:55808
  ds_write_b32 v25, v26
  buffer_load_dwordx4 v9, s[52:55], s4 offen offset:2048 lds
  v_add_u32 v26, 1, v26
  s_waitcnt lgkmcnt(9)
  v_mfma_f32_32x32x16_bf16 v[64:79], a[48:51], v[100:103], v[64:79]
  ds_read_b128 v[44:47], v18 offset:28672
  s_waitcnt lgkmcnt(9)
  v_mfma_f32_32x32x16_bf16 v[80:95], a[48:51], v[104:107], v[80:95]
  ds_read_b128 v[48:51], v19 offset:24576
  buffer_load_dwordx4 v10, s[52:55], s4 offen offset:3072 lds
  s_waitcnt lgkmcnt(5)
  v_mfma_f32_32x32x16_bf16 v[64:79], a[52:55], v[108:111], v[64:79]
  ds_read_b128 v[52:55], v19 offset:28672
  s_add_u32 m0, s89, 73728
  s_add_u32 s4, s85, 896
  buffer_load_dwordx4 v11, s[48:51], s4 offen offset:0 lds
  s_waitcnt lgkmcnt(2)
  v_mfma_f32_32x32x16_bf16 v[80:95], a[52:55], v[44:47], v[80:95]
  ds_read_b128 v[56:59], v20 offset:24576
  ds_read_b32 v28, v24 offset:0
  buffer_load_dwordx4 v12, s[48:51], s4 offen offset:1024 lds
  s_waitcnt lgkmcnt(3)
  v_mfma_f32_32x32x16_bf16 v[64:79], a[56:59], v[48:51], v[64:79]
  ds_read_b128 v[60:63], v20 offset:28672
  s_waitcnt lgkmcnt(1)
  v_cmp_gt_u32 vcc, 5, v28
  v_mfma_f32_32x32x16_bf16 v[80:95], a[56:59], v[52:55], v[80:95]
  s_cbranch_vccnz L_sp_10
L_sd_11:
  ds_read_b128 v[96:99], v17 offset:32768
  ds_read_b64_tr_b16 a[64:65], v21 offset:0
  ds_read_b64_tr_b16 a[66:67], v21 offset:512
  s_add_u32 m0, s88, 49152
  s_add_u32 s4, s86, 1605632
  buffer_load_dwordx4 v7, s[52:55], s4 offen offset:0 lds
  v_mfma_f32_32x32x16_bf16 v[64:79], a[60:63], v[56:59], v[64:79]
  ds_read_b128 v[100:103], v17 offset:36864
  ds_read_b64_tr_b16 a[68:69], v21 offset:2048
  ds_read_b64_tr_b16 a[70:71], v21 offset:2560
  ds_read_b64_tr_b16 a[72:73], v21 offset:4096
  ds_read_b64_tr_b16 a[74:75], v21 offset:4608
  buffer_load_dwordx4 v8, s[52:55], s4 offen offset:1024 lds
  s_waitcnt vmcnt(10) lgkmcnt(8)
  v_mfma_f32_32x32x16_bf16 v[80:95], a[60:63], v[60:63], v[80:95]
  ds_read_b128 v[104:107], v18 offset:32768
  ds_read_b64_tr_b16 a[76:77], v21 offset:6144
  ds_read_b64_tr_b16 a[78:79], v21 offset:6656
  ds_write_b32 v25, v26
  buffer_load_dwordx4 v9, s[52:55], s4 offen offset:2048 lds
  v_add_u32 v26, 1, v26
  s_waitcnt lgkmcnt(9)
  v_mfma_f32_32x32x16_bf16 v[64:79], a[64:67], v[96:99], v[64:79]
  ds_read_b128 v[108:111], v18 offset:36864
  s_waitcnt lgkmcnt(9)
  v_mfma_f32_32x32x16_bf16 v[80:95], a[64:67], v[100:103], v[80:95]
  ds_read_b128 v[44:47], v19 offset:32768
  buffer_load_dwordx4 v10, s[52:55], s4 offen offset:3072 lds
  s_waitcnt lgkmcnt(5)
  v_mfma_f32_32x32x16_bf16 v[64:79], a[68:71], v[104:107], v[64:79]
  ds_read_b128 v[48:51], v19 offset:36864
  s_add_u32 m0, s89, 81920
  s_add_u32 s4, s5, 0
  buffer_load_dwordx4 v11, s[48:51], s4 offen offset:0 lds
  s_waitcnt lgkmcnt(2)
  v_mfma_f32_32x32x16_bf16 v[80:95], a[68:71], v[108:111], v[80:95]
  ds_read_b128 v[52:55], v20 offset:32768
  ds_read_b32 v28, v24 offset:0
  buffer_load_dwordx4 v12, s[48:51], s4 offen offset:1024 lds
  s_waitcnt lgkmcnt(3)
  v_mfma_f32_32x32x16_bf16 v[64:79], a[72:75], v[44:47], v[64:79]
  ds_read_b128 v[56:59], v20 offset:36864
  s_waitcnt lgkmcnt(1)
  v_cmp_gt_u32 vcc, 6, v28
  v_mfma_f32_32x32x16_bf16 v[80:95], a[72:75], v[48:51], v[80:95]
  s_cbranch_vccnz L_sp_13
L_sd_14:
  ds_read_b128 v[60:63], v17 offset:40960
  ds_read_b64_tr_b16 a[80:81], v21 offset:16384
  ds_read_b64_tr_b16 a[82:83], v21 offset:16896
  s_add_u32 m0, s89, 90112
  s_add_u32 s4, s5, 128
  buffer_load_dwordx4 v11, s[48:51], s4 offen offset:0 lds
  v_mfma_f32_32x32x16_bf16 v[64:79], a[76:79], v[52:55], v[64:79]
  ds_read_b128 v[96:99], v17 offset:45056
  ds_read_b64_tr_b16 a[84:85], v21 offset:18432
  ds_read_b64_tr_b16 a[86:87], v21 offset:18944
  ds_read_b64_tr_b16 a[88:89], v21 offset:20480
  ds_read_b64_tr_b16 a[90:91], v21 offset:20992
  s_waitcnt vmcnt(9) lgkmcnt(8)
  v_mfma_f32_32x32x16_bf16 v[80:95], a[76:79], v[56:59], v[80:95]
  ds_read_b128 v[100:103], v18 offset:40960
  ds_read_b64_tr_b16 a[92:93], v21 offset:22528
  ds_read_b64_tr_b16 a[94:95], v21 offset:23040
  ds_write_b32 v25, v26
  v_add_u32 v26, 1, v26
  s_waitcnt lgkmcnt(9)
  v_mfma_f32_32x32x16_bf16 v[64:79], a[80:83], v[60:63], v[64:79]
  ds_read_b128 v[104:107], v18 offset:45056
  s_waitcnt lgkmcnt(9)
  v_mfma_f32_32x32x16_bf16 v[80:95], a[80:83], v[96:99], v[80:95]
  ds_read_b128 v[108:111], v19 offset:40960
  buffer_load_dwordx4 v12, s[48:51], s4 offen offset:1024 lds
  s_waitcnt lgkmcnt(5)
  v_mfma_f32_32x32x16_bf16 v[64:79], a[84:87], v[100:103], v[64:79]
  ds_read_b128 v[44:47], v19 offset:45056
  s_waitcnt lgkmcnt(2)
  v_mfma_f32_32x32x16_bf16 v[80:95], a[84:87], v[104:107], v[80:95]
  ds_read_b128 v[48:51], v20 offset:40960
  ds_read_b32 v28, v24 offset:0
  s_waitcnt lgkmcnt(3)
  v_mfma_f32_32x32x16_bf16 v[64:79], a[88:91], v[108:111], v[64:79]
  ds_read_b128 v[52:55], v20 offset:45056
  s_waitcnt lgkmcnt(1)
  v_cmp_gt_u32 vcc, 7, v28
  v_mfma_f32_32x32x16_bf16 v[80:95], a[88:91], v[44:47], v[80:95]
  s_cbranch_vccnz L_sp_16
L_sd_17:
  ds_read_b128 v[56:59], v17 offset:0
  ds_read_b64_tr_b16 a[96:97], v21 offset:32768
  ds_read_b64_tr_b16 a[98:99], v21 offset:33280
  s_add_u32 m0, s89, 98304
  s_add_u32 s4, s5, 256
  buffer_load_dwordx4 v11, s[48:51], s4 offen offset:0 lds
  v_mfma_f32_32x32x16_bf16 v[64:79], a[92:95], v[48:51], v[64:79]
  ds_read_b128 v[60:63], v17 offset:4096
  ds_read_b64_tr_b16 a[100:101], v21 offset:34816
  ds_read_b64_tr_b16 a[102:103], v21 offset:35328
  ds_read_b64_tr_b16 a[104:105], v21 offset:36864
  ds_read_b64_tr_b16 a[106:107], v21 offset:37376
  s_waitcnt vmcnt(5) lgkmcnt(8)
  v_mfma_f32_32x32x16_bf16 v[80:95], a[92:95], v[52:55], v[80:95]
  ds_read_b128 v[96:99], v18 offset:0
  ds_read_b64_tr_b16 a[108:109], v21 offset:38912
  ds_read_b64_tr_b16 a[110:111], v21 offset:39424
  ds_write_b32 v25, v26
  v_add_u32 v26, 1, v26
  s_waitcnt lgkmcnt(9)
  v_mfma_f32_32x32x16_bf16 v[64:79], a[96:99], v[56:59], v[64:79]
  ds_read_b128 v[100:103], v18 offset:4096
  s_waitcnt lgkmcnt(9)
  v_mfma_f32_32x32x16_bf16 v[80:95], a[96:99], v[60:63], v[80:95]
  ds_read_b128 v[104:107], v19 offset:0
  buffer_load_dwordx4 v12, s[48:51], s4 offen offset:1024 lds
  s_waitcnt lgkmcnt(5)
  v_mfma_f32_32x32x16_bf16 v[64:79], a[100:103], v[96:99], v[64:79]
  ds_read_b128 v[108:111], v19 offset:4096
  s_waitcnt lgkmcnt(2)
  v_mfma_f32_32x32x16_bf16 v[80:95], a[100:103], v[100:103], v[80:95]
  ds_read_b128 v[44:47], v20 offset:0
  ds_read_b32 v28, v24 offset:0
  s_waitcnt lgkmcnt(3)
  v_mfma_f32_32x32x16_bf16 v[64:79], a[104:107], v[104:107], v[64:79]
  ds_read_b128 v[48:51], v20 offset:4096
  s_waitcnt lgkmcnt(1)
  v_cmp_gt_u32 vcc, 8, v28
  v_mfma_f32_32x32x16_bf16 v[80:95], a[104:107], v[108:111], v[80:95]
  s_cbranch_vccnz L_sp_19
L_sd_20:
  ds_read_b128 v[52:55], v17 offset:8192
  ds_read_b64_tr_b16 a[112:113], v21 offset:49152
  ds_read_b64_tr_b16 a[114:115], v21 offset:49664
  s_add_u32 m0, s89, 106496
  s_add_u32 s4, s5, 384
  buffer_load_dwordx4 v11, s[48:51], s4 offen offset:0 lds
  v_mfma_f32_32x32x16_bf16 v[64:79], a[108:111], v[44:47], v[64:79]
  ds_read_b128 v[56:59], v17 offset:12288
  ds_read_b64_tr_b16 a[116:117], v21 offset:51200
  ds_read_b64_tr_b16 a[118:119], v21 offset:51712
  ds_read_b64_tr_b16 a[120:121], v21 offset:53248
  ds_read_b64_tr_b16 a[122:123], v21 offset:53760
  s_waitcnt vmcnt(5) lgkmcnt(8)
  v_mfma_f32_32x32x16_bf16 v[80:95], a[108:111], v[48:51], v[80:95]
  ds_read_b128 v[60:63], v18 offset:8192
  ds_read_b64_tr_b16 a[124:125], v21 offset:55296
  ds_read_b64_tr_b16 a[126:127], v21 offset:55808
  ds_write_b32 v25, v26
  v_add_u32 v26, 1, v26
  s_waitcnt lgkmcnt(9)
  v_mfma_f32_32x32x16_bf16 v[64:79], a[112:115], v[52:55], v[64:79]
  ds_read_b128 v[96:99], v18 offset:12288
  v_mov_b32 v35, 163632
  ds_read_b64 v[30:31], v35
  s_waitcnt lgkmcnt(10)
  v_mfma_f32_32x32x16_bf16 v[80:95], a[112:115], v[56:59], v[80:95]
  ds_read_b128 v[44:47], v19 offset:8192
  ds_read_b32 v29, v24 offset:16
  buffer_load_dwordx4 v12, s[48:51], s4 offen offset:1024 lds
  s_waitcnt lgkmcnt(7)
  v_mfma_f32_32x32x16_bf16 v[64:79], a[116:119], v[60:63], v[64:79]
  ds_read_b128 v[48:51], v19 offset:12288
  s_waitcnt lgkmcnt(4)
  v_mfma_f32_32x32x16_bf16 v[80:95], a[116:119], v[96:99], v[80:95]
  ds_read_b128 v[52:55], v20 offset:8192
  ds_read_b32 v28, v24 offset:0
  s_waitcnt lgkmcnt(5)
  v_cmp_eq_u32 vcc, 0, v30
  s_cbranch_vccnz L_np_49
L_nd_50:
  v_readfirstlane_b32 s64, v30
  v_readfirstlane_b32 s65, v31
  s_waitcnt lgkmcnt(4)
  v_mfma_f32_32x32x16_bf16 v[64:79], a[120:123], v[44:47], v[64:79]
  ds_read_b128 v[56:59], v20 offset:12288
  s_waitcnt lgkmcnt(1)
  v_cmp_gt_u32 vcc, 9, v28
  v_mfma_f32_32x32x16_bf16 v[80:95], a[120:123], v[48:51], v[80:95]
  s_cbranch_vccnz L_sp_22
L_sd_23:
  ds_read_b128 v[60:63], v17 offset:16384
  s_add_u32 m0, s89, 65536
  s_add_u32 s4, s5, 512
  buffer_load_dwordx4 v11, s[48:51], s4 offen offset:0 lds
  v_mfma_f32_32x32x16_bf16 v[64:79], a[124:127], v[52:55], v[64:79]
  ds_read_b128 v[44:47], v17 offset:20480
  v_cmp_gt_u32 vcc, 3, v29
  s_cbranch_vccnz L_sp_52
L_sd_53:
  s_waitcnt vmcnt(5) lgkmcnt(2)
  v_mfma_f32_32x32x16_bf16 v[80:95], a[124:127], v[56:59], v[80:95]
  ds_read_b128 v[48:51], v18 offset:16384
  ds_write_b32 v25, v26
  v_add_u32 v26, 1, v26
  s_waitcnt lgkmcnt(3)
  v_mfma_f32_32x32x16_bf16 v[96:111], a[0:3], v[60:63], 0
  ds_read_b128 v[52:55], v18 offset:20480
  s_waitcnt lgkmcnt(3)
  v_mfma_f32_32x32x16_bf16 v[112:127], a[0:3], v[44:47], 0
  v_cvt_pk_bf16_f32 v64, v64, v65
  v_cvt_pk_bf16_f32 v65, v66, v67
  v_cvt_pk_bf16_f32 v66, v68, v69
  v_cvt_pk_bf16_f32 v67, v70, v71
  ds_write_b128 v1, v[64:67] offset:0
  ds_read_b128 v[56:59], v19 offset:16384
  buffer_load_dwordx4 v12, s[48:51], s4 offen offset:1024 lds
  s_waitcnt lgkmcnt(4)
  v_mfma_f32_32x32x16_bf16 v[96:111], a[4:7], v[48:51], v[96:111]
  v_cvt_pk_bf16_f32 v72, v72, v73
  v_cvt_pk_bf16_f32 v73, v74, v75
  v_cvt_pk_bf16_f32 v74, v76, v77
  v_cvt_pk_bf16_f32 v75, v78, v79
  ds_write_b128 v1, v[72:75] offset:1024
  ds_write_b32 v25, v26 offset:32
  ds_read_b128 v[60:63], v19 offset:20480
  s_waitcnt lgkmcnt(5)
  v_mfma_f32_32x32x16_bf16 v[112:127], a[4:7], v[52:55], v[112:127]
  ds_read_b128 v[44:47], v20 offset:16384
  ds_read_b32 v28, v24 offset:0
  s_waitcnt lgkmcnt(5)
  v_mfma_f32_32x32x16_bf16 v[96:111], a[8:11], v[56:59], v[96:111]
  v_cvt_pk_bf16_f32 v80, v80, v81
  v_cvt_pk_bf16_f32 v81, v82, v83
  v_cvt_pk_bf16_f32 v82, v84, v85
  v_cvt_pk_bf16_f32 v83, v86, v87
  ds_write_b128 v1, v[80:83] offset:2048
  ds_read_b128 v[48:51], v20 offset:20480
  s_waitcnt lgkmcnt(2)
  v_cmp_gt_u32 vcc, 10, v28
  v_mfma_f32_32x32x16_bf16 v[112:127], a[8:11], v[60:63], v[112:127]
  s_cbranch_vccnz L_sp_25
L_sd_26:
  ds_read_b128 v[52:55], v17 offset:24576
  s_add_u32 m0, s89, 73728
  s_add_u32 s4, s5, 640
  buffer_load_dwordx4 v11, s[48:51], s4 offen offset:0 lds
  v_mfma_f32_32x32x16_bf16 v[96:111], a[12:15], v[44:47], v[96:111]
  v_cvt_pk_bf16_f32 v88, v88, v89
  v_cvt_pk_bf16_f32 v89, v90, v91
  v_cvt_pk_bf16_f32 v90, v92, v93
  v_cvt_pk_bf16_f32 v91, v94, v95
  ds_write_b128 v1, v[88:91] offset:3072
  ds_read_b128 v[56:59], v17 offset:28672
  buffer_load_dwordx4 v12, s[48:51], s4 offen offset:1024 lds
  s_waitcnt vmcnt(6) lgkmcnt(3)
  v_mfma_f32_32x32x16_bf16 v[112:127], a[12:15], v[48:51], v[112:127]
  ds_read_b128 v[60:63], v18 offset:24576
  ds_write_b32 v25, v26
  s_lshl_b32 s4, s78, 17
  s_add_u32 m0, s88, 0
  s_add_u32 s4, s4, s87
  buffer_load_dwordx4 v13, s[56:59], s4 offen offset:0 lds
  v_add_u32 v26, 1, v26
  s_waitcnt lgkmcnt(4)
  v_mfma_f32_32x32x16_bf16 v[96:111], a[16:19], v[52:55], v[96:111]
  ds_read_b128 v[44:47], v18 offset:28672
  s_waitcnt lgkmcnt(3)
  v_mfma_f32_32x32x16_bf16 v[112:127], a[16:19], v[56:59], v[112:127]
  ds_read_b128 v[48:51], v19 offset:24576
  buffer_load_dwordx4 v14, s[56:59], s4 offen offset:1024 lds
  s_waitcnt lgkmcnt(3)
  v_mfma_f32_32x32x16_bf16 v[96:111], a[20:23], v[60:63], v[96:111]
  ds_read_b128 v[52:55], v19 offset:28672
  s_lshl_b32 s4, s78, 17
  s_add_u32 m0, s88, 0
  s_add_u32 s4, s4, s87
  buffer_load_dwordx4 v15, s[56:59], s4 offen offset:2048 lds
  s_waitcnt lgkmcnt(2)
  v_mfma_f32_32x32x16_bf16 v[112:127], a[20:23], v[44:47], v[112:127]
  ds_read_b128 v[56:59], v20 offset:24576
  ds_read_b32 v28, v24 offset:0
  buffer_load_dwordx4 v16, s[56:59], s4 offen offset:3072 lds
  s_waitcnt lgkmcnt(3)
  v_mfma_f32_32x32x16_bf16 v[96:111], a[24:27], v[48:51], v[96:111]
  ds_read_b128 v[60:63], v20 offset:28672
  s_waitcnt lgkmcnt(1)
  v_cmp_gt_u32 vcc, 11, v28
  v_mfma_f32_32x32x16_bf16 v[112:127], a[24:27], v[52:55], v[112:127]
  s_cbranch_vccnz L_sp_28
L_sd_29:
  ds_read_b128 v[44:47], v17 offset:32768
  s_add_u32 m0, s89, 81920
  s_add_u32 s4, s5, 768
  buffer_load_dwordx4 v11, s[48:51], s4 offen offset:0 lds
  v_mfma_f32_32x32x16_bf16 v[96:111], a[28:31], v[56:59], v[96:111]
  ds_read_b128 v[48:51], v17 offset:36864
  buffer_load_dwordx4 v12, s[48:51], s4 offen offset:1024 lds
  s_waitcnt vmcnt(10) lgkmcnt(2)
  v_mfma_f32_32x32x16_bf16 v[112:127], a[28:31], v[60:63], v[112:127]
  ds_read_b128 v[52:55], v18 offset:32768
  ds_write_b32 v25, v26
  s_lshl_b32 s4, s79, 17
  s_add_u32 m0, s88, 16384
  s_add_u32 s4, s4, s87
  buffer_load_dwordx4 v13, s[56:59], s4 offen offset:0 lds
  v_add_u32 v26, 1, v26
  s_waitcnt lgkmcnt(3)
  v_mfma_f32_32x32x16_bf16 v[96:111], a[32:35], v[44:47], v[96:111]
  ds_read_b128 v[56:59], v18 offset:36864
  s_waitcnt lgkmcnt(3)
  v_mfma_f32_32x32x16_bf16 v[112:127], a[32:35], v[48:51], v[112:127]
  ds_read_b128 v[60:63], v19 offset:32768
  buffer_load_dwordx4 v14, s[56:59], s4 offen offset:1024 lds
  s_waitcnt lgkmcnt(3)
  v_mfma_f32_32x32x16_bf16 v[96:111], a[36:39], v[52:55], v[96:111]
  ds_read_b128 v[44:47], v19 offset:36864
  s_lshl_b32 s4, s79, 17
  s_add_u32 m0, s88, 16384
  s_add_u32 s4, s4, s87
  buffer_load_dwordx4 v15, s[56:59], s4 offen offset:2048 lds
  s_waitcnt lgkmcnt(2)
  v_mfma_f32_32x32x16_bf16 v[112:127], a[36:39], v[56:59], v[112:127]
  ds_read_b128 v[48:51], v20 offset:32768
  ds_read_b32 v28, v24 offset:0
  buffer_load_dwordx4 v16, s[56:59], s4 offen offset:3072 lds
  s_waitcnt lgkmcnt(3)
  v_mfma_f32_32x32x16_bf16 v[96:111], a[40:43], v[60:63], v[96:111]
  ds_read_b128 v[52:55], v20 offset:36864
  s_waitcnt lgkmcnt(1)
  v_cmp_gt_u32 vcc, 12, v28
  v_mfma_f32_32x32x16_bf16 v[112:127], a[40:43], v[44:47], v[112:127]
  s_cbranch_vccnz L_sp_31
L_sd_32:
  ds_read_b128 v[56:59], v17 offset:40960
  s_add_u32 m0, s89, 90112
  s_add_u32 s4, s5, 896
  buffer_load_dwordx4 v11, s[48:51], s4 offen offset:0 lds
  v_mfma_f32_32x32x16_bf16 v[96:111], a[44:47], v[48:51], v[96:111]
  ds_read_b128 v[60:63], v17 offset:45056
  buffer_load_dwordx4 v12, s[48:51], s4 offen offset:1024 lds
  s_waitcnt vmcnt(14) lgkmcnt(2)
  v_mfma_f32_32x32x16_bf16 v[112:127], a[44:47], v[52:55], v[112:127]
  ds_read_b128 v[44:47], v18 offset:40960
  ds_write_b32 v25, v26
  s_lshl_b32 s4, s80, 17
  s_add_u32 m0, s88, 32768
  s_add_u32 s4, s4, s87
  buffer_load_dwordx4 v13, s[56:59], s4 offen offset:0 lds
  v_add_u32 v26, 1, v26
  s_waitcnt lgkmcnt(3)
  v_mfma_f32_32x32x16_bf16 v[96:111], a[48:51], v[56:59], v[96:111]
  ds_read_b128 v[48:51], v18 offset:45056
  s_waitcnt lgkmcnt(3)
  v_mfma_f32_32x32x16_bf16 v[112:127], a[48:51], v[60:63], v[112:127]
  ds_read_b128 v[52:55], v19 offset:40960
  buffer_load_dwordx4 v14, s[56:59], s4 offen offset:1024 lds
  s_waitcnt lgkmcnt(3)
  v_mfma_f32_32x32x16_bf16 v[96:111], a[52:55], v[44:47], v[96:111]
  ds_read_b128 v[56:59], v19 offset:45056
  s_lshl_b32 s4, s80, 17
  s_add_u32 m0, s88, 32768
  s_add_u32 s4, s4, s87
  buffer_load_dwordx4 v15, s[56:59], s4 offen offset:2048 lds
  s_waitcnt lgkmcnt(2)
  v_mfma_f32_32x32x16_bf16 v[112:127], a[52:55], v[48:51], v[112:127]
  ds_read_b128 v[60:63], v20 offset:40960
  ds_read_b32 v28, v24 offset:0
  buffer_load_dwordx4 v16, s[56:59], s4 offen offset:3072 lds
  s_waitcnt lgkmcnt(3)
  v_mfma_f32_32x32x16_bf16 v[96:111], a[56:59], v[52:55], v[96:111]
  ds_read_b128 v[44:47], v20 offset:45056
  s_waitcnt lgkmcnt(1)
  v_cmp_gt_u32 vcc, 13, v28
  v_mfma_f32_32x32x16_bf16 v[112:127], a[56:59], v[56:59], v[112:127]
  s_cbranch_vccnz L_sp_34
L_sd_35:
  ds_read_b128 v[48:51], v17 offset:0
  s_lshl_b32 s4, s81, 17
  s_add_u32 m0, s88, 49152
  s_add_u32 s4, s4, s87
  buffer_load_dwordx4 v13, s[56:59], s4 offen offset:0 lds
  v_mfma_f32_32x32x16_bf16 v[96:111], a[60:63], v[60:63], v[96:111]
  ds_read_b128 v[52:55], v17 offset:4096
  s_waitcnt vmcnt(17) lgkmcnt(2)
  v_mfma_f32_32x32x16_bf16 v[112:127], a[60:63], v[44:47], v[112:127]
  ds_read_b128 v[56:59], v18 offset:0
  ds_write_b32 v25, v26
  buffer_load_dwordx4 v14, s[56:59], s4 offen offset:1024 lds
  v_add_u32 v26, 1, v26
  s_waitcnt lgkmcnt(3)
  v_mfma_f32_32x32x16_bf16 v[96:111], a[64:67], v[48:51], v[96:111]
  ds_read_b128 v[60:63], v18 offset:4096
  ds_read_b32 v29, v24 offset:16
  v_and_b32 v93, 15, v4
  v_lshrrev_b32 v94, 4, v4
  v_lshl_add_u32 v88, v93, 2, v94
  v_lshlrev_b32 v88, 3, v88
  s_mul_i32 s95, s43, 4608
  s_waitcnt lgkmcnt(4)
  v_mfma_f32_32x32x16_bf16 v[112:127], a[64:67], v[52:55], v[112:127]
  ds_read_b128 v[44:47], v19 offset:0
  s_lshl_b32 s4, s81, 17
  s_add_u32 m0, s88, 49152
  s_add_u32 s4, s4, s87
  buffer_load_dwordx4 v15, s[56:59], s4 offen offset:2048 lds
  s_lshl_b32 s86, s42, 11
  s_sub_u32 s95, s95, s86
  s_waitcnt lgkmcnt(4)
  v_mfma_f32_32x32x16_bf16 v[96:111], a[68:71], v[56:59], v[96:111]
  ds_read_b128 v[48:51], v19 offset:4096
  s_add_u32 s95, s95, 117240
  v_sub_u32 v88, s95, v88
  s_waitcnt lgkmcnt(2)
  v_cmp_gt_u32 vcc, 5, v29
  s_cbranch_vccnz L_sp_55
L_sd_56:
  ds_read_b64 v[80:81], v88 offset:1536
  v_mfma_f32_32x32x16_bf16 v[112:127], a[68:71], v[60:63], v[112:127]
  ds_read_b128 v[52:55], v20 offset:0
  ds_read_b32 v28, v24 offset:0
  buffer_load_dwordx4 v16, s[56:59], s4 offen offset:3072 lds
  ds_read_b64 v[82:83], v88 offset:1024
  ds_read_b64 v[84:85], v88 offset:512
  ds_read_b64 v[86:87], v88 offset:0
  s_lshl_b32 s95, s43, 13
  s_waitcnt lgkmcnt(7)
  v_mfma_f32_32x32x16_bf16 v[96:111], a[72:75], v[44:47], v[96:111]
  ds_read_b128 v[56:59], v20 offset:4096
  s_waitcnt lgkmcnt(4)
  v_cmp_gt_u32 vcc, 14, v28
  v_mfma_f32_32x32x16_bf16 v[112:127], a[72:75], v[48:51], v[112:127]
  s_cbranch_vccnz L_sp_37
L_sd_38:
  ds_read_b128 v[60:63], v17 offset:8192
  s_lshl_b32 s4, s82, 17
  s_add_u32 m0, s88, 98304
  s_add_u32 s4, s4, s87
  buffer_load_dwordx4 v13, s[56:59], s4 offen offset:0 lds
  s_lshl_b32 s86, s42, 14
  v_mfma_f32_32x32x16_bf16 v[96:111], a[76:79], v[52:55], v[96:111]
  ds_read_b128 v[44:47], v17 offset:12288
  s_sub_u32 s95, s95, s86
  s_add_u32 s95, s95, 140288
  v_add_u32 v89, s95, v5
  s_lshl_b32 s95, s43, 4
  s_lshr_b32 s94, s94, s95
  s_lshl_b32 s94, s94, 16
  s_waitcnt vmcnt(15) lgkmcnt(2)
  v_mfma_f32_32x32x16_bf16 v[112:127], a[76:79], v[56:59], v[112:127]
  ds_read_b128 v[48:51], v18 offset:8192
  ds_write_b32 v25, v26
  v_add_u32 v26, 1, v26
  v_and_b32 v90, 3, v93
  v_lshlrev_b32 v90, 4, v90
  v_lshrrev_b32 v93, 2, v93
  s_waitcnt lgkmcnt(3)
  v_mfma_f32_32x32x16_bf16 v[96:111], a[80:83], v[60:63], v[96:111]
  ds_read_b128 v[52:55], v18 offset:12288
  v_lshl_add_u32 v90, v93, 7, v90
  v_and_b32 v93, 1, v94
  v_lshl_add_u32 v90, v93, 9, v90
  v_lshrrev_b32 v93, 1, v94
  v_lshl_add_u32 v90, v93, 6, v90
  v_lshlrev_b32 v93, 26, v94
  s_waitcnt lgkmcnt(3)
  v_mfma_f32_32x32x16_bf16 v[112:127], a[80:83], v[44:47], v[112:127]
  ds_read_b128 v[56:59], v19 offset:8192
  buffer_load_dwordx4 v14, s[56:59], s4 offen offset:1024 lds
  v_lshl_add_u32 v91, v4, 11, v93
  s_lshl_b32 s86, s7, 5
  s_add_u32 s86, s86, s8
  s_lshl1_add_u32 s86, s86, s43
  s_lshl1_add_u32 s95, s86, s42
  s_waitcnt lgkmcnt(3)
  v_mfma_f32_32x32x16_bf16 v[96:111], a[84:87], v[48:51], v[96:111]
  ds_read_b128 v[60:63], v19 offset:12288
  s_lshl_b32 s95, s95, 11
  s_add_u32 s95, s95, 25165824
  s_lshl_b32 s86, s86, 2
  s_add_u32 s86, s86, 28573696
  v_mov_b32 v93, s42
  v_lshl_add_u32 v91, v93, 15, v91
  s_waitcnt lgkmcnt(2)
  v_mfma_f32_32x32x16_bf16 v[112:127], a[84:87], v[52:55], v[112:127]
  ds_read_b128 v[44:47], v20 offset:8192
  ds_read_b32 v28, v24 offset:0
  v_and_b32 v64, s0, v81
  v_lshlrev_b32 v65, 16, v81
  v_and_b32 v66, s0, v80
  v_lshlrev_b32 v67, 16, v80
  s_waitcnt lgkmcnt(3)
  v_mfma_f32_32x32x16_bf16 v[96:111], a[88:91], v[56:59], v[96:111]
  ds_read_b128 v[48:51], v20 offset:12288
  s_waitcnt lgkmcnt(1)
  v_cmp_gt_u32 vcc, 15, v28
  v_mfma_f32_32x32x16_bf16 v[112:127], a[88:91], v[60:63], v[112:127]
  s_cbranch_vccnz L_sp_40
L_sd_41:
  ds_read_b128 v[52:55], v17 offset:16384
  s_lshl_b32 s4, s82, 17
  s_add_u32 m0, s88, 98304
  s_add_u32 s4, s4, s87
  buffer_load_dwordx4 v15, s[56:59], s4 offen offset:2048 lds
  v_and_b32 v68, s0, v83
  v_mfma_f32_32x32x16_bf16 v[96:111], a[92:95], v[44:47], v[96:111]
  ds_read_b128 v[56:59], v17 offset:20480
  v_lshlrev_b32 v69, 16, v83
  v_and_b32 v70, s0, v82
  v_lshlrev_b32 v71, 16, v82
  v_and_b32 v72, s0, v85
  v_lshlrev_b32 v73, 16, v85
  v_and_b32 v74, s0, v84
  s_waitcnt vmcnt(11) lgkmcnt(2)
  v_mfma_f32_32x32x16_bf16 v[112:127], a[92:95], v[48:51], v[112:127]
  ds_read_b128 v[60:63], v18 offset:16384
  ds_write_b32 v25, v26
  v_add_u32 v26, 1, v26
  v_lshlrev_b32 v75, 16, v84
  v_and_b32 v76, s0, v87
  v_lshlrev_b32 v77, 16, v87
  s_waitcnt lgkmcnt(3)
  v_mfma_f32_32x32x16_bf16 v[96:111], a[96:99], v[52:55], v[96:111]
  ds_read_b128 v[44:47], v18 offset:20480
  v_and_b32 v78, s0, v86
  v_lshlrev_b32 v79, 16, v86
  v_mul_f32 v64, s94, v64
  v_mul_f32 v65, s94, v65
  v_mul_f32 v66, s94, v66
  v_mul_f32 v67, s94, v67
  s_waitcnt lgkmcnt(3)
  v_mfma_f32_32x32x16_bf16 v[112:127], a[96:99], v[56:59], v[112:127]
  ds_read_b128 v[48:51], v19 offset:16384
  buffer_load_dwordx4 v16, s[56:59], s4 offen offset:3072 lds
  v_mul_f32 v68, s94, v68
  v_mul_f32 v69, s94, v69
  v_mul_f32 v70, s94, v70
  v_mul_f32 v71, s94, v71
  v_mul_f32 v72, s94, v72
  s_waitcnt lgkmcnt(3)
  v_mfma_f32_32x32x16_bf16 v[96:111], a[100:103], v[60:63], v[96:111]
  ds_read_b128 v[52:55], v19 offset:20480
  v_mul_f32 v73, s94, v73
  v_mul_f32 v74, s94, v74
  v_mul_f32 v75, s94, v75
  v_mul_f32 v76, s94, v76
  v_mul_f32 v77, s94, v77
  v_mul_f32 v78, s94, v78
  s_waitcnt lgkmcnt(2)
  v_mfma_f32_32x32x16_bf16 v[112:127], a[100:103], v[44:47], v[112:127]
  ds_read_b128 v[56:59], v20 offset:16384
  ds_read_b32 v28, v24 offset:0
  v_mul_f32 v79, s94, v79
  v_cvt_pk_bf16_f32 v64, 0, v64
  v_cvt_pk_bf16_f32 v65, 0, v65
  v_cvt_pk_bf16_f32 v66, 0, v66
  v_cvt_pk_bf16_f32 v67, 0, v67
  s_waitcnt lgkmcnt(3)
  v_mfma_f32_32x32x16_bf16 v[96:111], a[104:107], v[48:51], v[96:111]
  ds_read_b128 v[60:63], v20 offset:20480
  s_waitcnt lgkmcnt(1)
  v_cmp_gt_u32 vcc, 16, v28
  v_mfma_f32_32x32x16_bf16 v[112:127], a[104:107], v[52:55], v[112:127]
  s_cbranch_vccnz L_sp_43
L_sd_44:
  ds_read_b128 v[44:47], v17 offset:24576
  s_lshl_b32 s4, s83, 17
  s_add_u32 m0, s88, 65536
  s_add_u32 s4, s4, s87
  buffer_load_dwordx4 v13, s[56:59], s4 offen offset:0 lds
  v_cvt_pk_bf16_f32 v68, 0, v68
  v_mfma_f32_32x32x16_bf16 v[96:111], a[108:111], v[56:59], v[96:111]
  ds_read_b128 v[48:51], v17 offset:28672
  v_cvt_pk_bf16_f32 v69, 0, v69
  v_cvt_pk_bf16_f32 v70, 0, v70
  v_cvt_pk_bf16_f32 v71, 0, v71
  v_cvt_pk_bf16_f32 v72, 0, v72
  v_cvt_pk_bf16_f32 v73, 0, v73
  v_cvt_pk_bf16_f32 v74, 0, v74
  s_waitcnt lgkmcnt(2)
  v_mfma_f32_32x32x16_bf16 v[112:127], a[108:111], v[60:63], v[112:127]
  ds_read_b128 v[52:55], v18 offset:24576
  ds_write_b32 v25, v26
  v_add_u32 v26, 1, v26
  v_cvt_pk_bf16_f32 v75, 0, v75
  v_cvt_pk_bf16_f32 v76, 0, v76
  v_cvt_pk_bf16_f32 v77, 0, v77
  v_cvt_pk_bf16_f32 v78, 0, v78
  s_waitcnt lgkmcnt(3)
  v_mfma_f32_32x32x16_bf16 v[96:111], a[112:115], v[44:47], v[96:111]
  ds_read_b128 v[56:59], v18 offset:28672
  v_cvt_pk_bf16_f32 v79, 0, v79
  v_mov_b32 v7, v22
  v_xor_b32 v8, 64, v22
  v_add_u32 v9, 0x10000, v22
  v_add_u32 v10, 0x10000, v8
  s_add_u32 s91, s91, 114688
  s_waitcnt lgkmcnt(3)
  v_mfma_f32_32x32x16_bf16 v[112:127], a[112:115], v[48:51], v[112:127]
  ds_read_b128 v[60:63], v19 offset:24576
  buffer_load_dwordx4 v14, s[56:59], s4 offen offset:1024 lds
  s_mov_b32 s70, 0
  s_waitcnt lgkmcnt(3)
  v_mfma_f32_32x32x16_bf16 v[96:111], a[116:119], v[52:55], v[96:111]
  ds_read_b128 v[44:47], v19 offset:28672
  s_waitcnt lgkmcnt(2)
  v_mfma_f32_32x32x16_bf16 v[112:127], a[116:119], v[56:59], v[112:127]
  ds_read_b128 v[48:51], v20 offset:24576
  ds_read_b32 v28, v24 offset:0
  s_waitcnt lgkmcnt(3)
  v_mfma_f32_32x32x16_bf16 v[96:111], a[120:123], v[60:63], v[96:111]
  ds_read_b128 v[52:55], v20 offset:28672
  s_waitcnt lgkmcnt(1)
  v_cmp_gt_u32 vcc, 17, v28
  v_mfma_f32_32x32x16_bf16 v[112:127], a[120:123], v[44:47], v[112:127]
  s_cbranch_vccnz L_sp_46
L_sd_47:
  s_lshl_b32 s4, s83, 17
  s_add_u32 m0, s88, 65536
  s_add_u32 s4, s4, s87
  buffer_load_dwordx4 v15, s[56:59], s4 offen offset:2048 lds
  v_mfma_f32_32x32x16_bf16 v[96:111], a[124:127], v[48:51], v[96:111]
  s_waitcnt lgkmcnt(0)
  v_mfma_f32_32x32x16_bf16 v[112:127], a[124:127], v[52:55], v[112:127]
  ds_write_b32 v25, v26
  buffer_load_dwordx4 v16, s[56:59], s4 offen offset:3072 lds
  v_add_u32 v26, 1, v26
  s_waitcnt vmcnt(12)
  ds_write_b32 v25, v26
  v_add_u32 v26, 1, v26
  s_setprio 1
  s_nop 7
  v_cvt_pk_bf16_f32 v96, 0, v96
  v_cvt_pk_bf16_f32 v97, 0, v97
  v_cvt_pk_bf16_f32 v98, 0, v98
  v_cvt_pk_bf16_f32 v99, 0, v99
  v_cvt_pk_bf16_f32 v100, 0, v100
  v_cvt_pk_bf16_f32 v101, 0, v101
  v_cvt_pk_bf16_f32 v102, 0, v102
  v_cvt_pk_bf16_f32 v103, 0, v103
  v_mul_f32 v36, v32, v96
  v_mul_f32 v37, v32, v97
  v_mul_f32 v38, v32, v98
  v_mul_f32 v39, v32, v99
  v_mul_f32 v40, v32, v100
  v_mul_f32 v41, v32, v101
  v_mul_f32 v42, v32, v102
  v_mul_f32 v43, v32, v103
  v_exp_f32 v36, v36
  v_exp_f32 v37, v37
  v_exp_f32 v38, v38
  v_exp_f32 v39, v39
  v_exp_f32 v40, v40
  v_exp_f32 v41, v41
  v_exp_f32 v42, v42
  v_exp_f32 v43, v43
  v_add_f32 v36, 1.0, v36
  v_add_f32 v37, 1.0, v37
  v_add_f32 v38, 1.0, v38
  v_add_f32 v39, 1.0, v39
  v_add_f32 v40, 1.0, v40
  v_add_f32 v41, 1.0, v41
  v_add_f32 v42, 1.0, v42
  v_add_f32 v43, 1.0, v43
  v_rcp_f32 v36, v36
  v_rcp_f32 v37, v37
  v_rcp_f32 v38, v38
  v_rcp_f32 v39, v39
  v_rcp_f32 v40, v40
  v_rcp_f32 v41, v41
  v_rcp_f32 v42, v42
  v_rcp_f32 v43, v43
  v_mul_f32 v96, v96, v36
  v_mul_f32 v97, v97, v37
  ds_read_b32 v28, v24 offset:0
  v_mul_f32 v98, v98, v38
  v_mul_f32 v99, v99, v39
  v_mul_f32 v100, v100, v40
  v_mul_f32 v101, v101, v41
  v_mul_f32 v102, v102, v42
  v_mul_f32 v103, v103, v43
  s_add_u32 s15, s90, 114688
  v_cvt_pk_bf16_f32 v96, v96, v97
  v_cvt_pk_bf16_f32 v97, v98, v99
  v_cvt_pk_bf16_f32 v98, v100, v101
  v_cvt_pk_bf16_f32 v99, v102, v103
  buffer_store_dwordx4 v[96:99], v5, s[72:75], s15 offen offset:0 sc1
  s_waitcnt lgkmcnt(0)
  v_cmp_gt_u32 vcc, 18, v28
  s_cbranch_vccnz L_sp_62
L_sd_63:
  v_cvt_pk_bf16_f32 v112, 0, v112
  s_lshl_b32 s4, s84, 17
  s_add_u32 m0, s88, 81920
  s_add_u32 s4, s4, s87
  buffer_load_dwordx4 v13, s[56:59], s4 offen offset:0 lds
  v_cvt_pk_bf16_f32 v113, 0, v113
  v_cvt_pk_bf16_f32 v114, 0, v114
  v_cvt_pk_bf16_f32 v115, 0, v115
  v_cvt_pk_bf16_f32 v116, 0, v116
  buffer_load_dwordx4 v14, s[56:59], s4 offen offset:1024 lds
  v_cvt_pk_bf16_f32 v117, 0, v117
  v_cvt_pk_bf16_f32 v118, 0, v118
  v_cvt_pk_bf16_f32 v119, 0, v119
  v_mul_f32 v36, v32, v112
  s_lshl_b32 s4, s84, 17
  s_add_u32 m0, s88, 81920
  s_add_u32 s4, s4, s87
  buffer_load_dwordx4 v15, s[56:59], s4 offen offset:2048 lds
  v_mul_f32 v37, v32, v113
  v_mul_f32 v38, v32, v114
  v_mul_f32 v39, v32, v115
  v_mul_f32 v40, v32, v116
  buffer_load_dwordx4 v16, s[56:59], s4 offen offset:3072 lds
  v_mul_f32 v41, v32, v117
  v_mul_f32 v42, v32, v118
  v_mul_f32 v43, v32, v119
  v_exp_f32 v36, v36
  v_exp_f32 v37, v37
  v_exp_f32 v38, v38
  v_exp_f32 v39, v39
  v_exp_f32 v40, v40
  v_exp_f32 v41, v41
  v_exp_f32 v42, v42
  v_exp_f32 v43, v43
  v_add_f32 v36, 1.0, v36
  v_add_f32 v37, 1.0, v37
  v_add_f32 v38, 1.0, v38
  v_add_f32 v39, 1.0, v39
  v_add_f32 v40, 1.0, v40
  v_add_f32 v41, 1.0, v41
  v_add_f32 v42, 1.0, v42
  v_add_f32 v43, 1.0, v43
  v_rcp_f32 v36, v36
  v_rcp_f32 v37, v37
  v_rcp_f32 v38, v38
  v_rcp_f32 v39, v39
  v_rcp_f32 v40, v40
  v_rcp_f32 v41, v41
  v_rcp_f32 v42, v42
  v_rcp_f32 v43, v43
  v_mul_f32 v112, v112, v36
  v_mul_f32 v113, v113, v37
  v_mul_f32 v114, v114, v38
  v_mul_f32 v115, v115, v39
  v_mul_f32 v116, v116, v40
  v_mul_f32 v117, v117, v41
  v_mul_f32 v118, v118, v42
  v_mul_f32 v119, v119, v43
  s_add_u32 s15, s90, 172032
  v_cvt_pk_bf16_f32 v112, v112, v113
  v_cvt_pk_bf16_f32 v113, v114, v115
  v_cvt_pk_bf16_f32 v114, v116, v117
  v_cvt_pk_bf16_f32 v115, v118, v119
  buffer_store_dwordx4 v[112:115], v5, s[72:75], s15 offen offset:0 sc1
  v_cvt_pk_bf16_f32 v104, 0, v104
  v_cvt_pk_bf16_f32 v105, 0, v105
  v_cvt_pk_bf16_f32 v106, 0, v106
  v_cvt_pk_bf16_f32 v107, 0, v107
  v_cvt_pk_bf16_f32 v108, 0, v108
  v_cvt_pk_bf16_f32 v109, 0, v109
  v_cvt_pk_bf16_f32 v110, 0, v110
  v_cvt_pk_bf16_f32 v111, 0, v111
  v_mul_f32 v36, v32, v104
  v_mul_f32 v37, v32, v105
  v_mul_f32 v38, v32, v106
  v_mul_f32 v39, v32, v107
  v_mul_f32 v40, v32, v108
  v_mul_f32 v41, v32, v109
  v_mul_f32 v42, v32, v110
  v_mul_f32 v43, v32, v111
  v_exp_f32 v36, v36
  v_exp_f32 v37, v37
  v_exp_f32 v38, v38
  v_exp_f32 v39, v39
  v_exp_f32 v40, v40
  v_exp_f32 v41, v41
  v_exp_f32 v42, v42
  v_exp_f32 v43, v43
  v_add_f32 v36, 1.0, v36
  v_add_f32 v37, 1.0, v37
  v_add_f32 v38, 1.0, v38
  v_add_f32 v39, 1.0, v39
  v_add_f32 v40, 1.0, v40
  v_add_f32 v41, 1.0, v41
  v_add_f32 v42, 1.0, v42
  v_add_f32 v43, 1.0, v43
  v_rcp_f32 v36, v36
  v_rcp_f32 v37, v37
  v_rcp_f32 v38, v38
  v_rcp_f32 v39, v39
  v_rcp_f32 v40, v40
  v_rcp_f32 v41, v41
  v_rcp_f32 v42, v42
  v_rcp_f32 v43, v43
  v_mul_f32 v104, v104, v36
  v_mul_f32 v105, v105, v37
  v_mul_f32 v106, v106, v38
  v_mul_f32 v107, v107, v39
  v_mul_f32 v108, v108, v40
  v_mul_f32 v109, v109, v41
  v_mul_f32 v110, v110, v42
  v_mul_f32 v111, v111, v43
  s_add_u32 s15, s90, 114688
  v_cvt_pk_bf16_f32 v104, v104, v105
  v_cvt_pk_bf16_f32 v105, v106, v107
  v_cvt_pk_bf16_f32 v106, v108, v109
  v_cvt_pk_bf16_f32 v107, v110, v111
  buffer_store_dwordx4 v[104:107], v5, s[72:75], s15 offen offset:1024 sc1
  v_cvt_pk_bf16_f32 v120, 0, v120
  v_cvt_pk_bf16_f32 v121, 0, v121
  v_cvt_pk_bf16_f32 v122, 0, v122
  v_cvt_pk_bf16_f32 v123, 0, v123
  v_cvt_pk_bf16_f32 v124, 0, v124
  v_cvt_pk_bf16_f32 v125, 0, v125
  v_cvt_pk_bf16_f32 v126, 0, v126
  v_cvt_pk_bf16_f32 v127, 0, v127
  v_mul_f32 v36, v32, v120
  v_mul_f32 v37, v32, v121
  v_mul_f32 v38, v32, v122
  v_mul_f32 v39, v32, v123
  v_mul_f32 v40, v32, v124
  v_mul_f32 v41, v32, v125
  s_waitcnt vmcnt(1)
  buffer_store_dword v30, v34, s[72:75], s92 offen offset:1664 sc1
  v_mul_f32 v42, v32, v126
  v_mul_f32 v43, v32, v127
  v_exp_f32 v36, v36
  v_exp_f32 v37, v37
  v_exp_f32 v38, v38
  v_exp_f32 v39, v39
  v_exp_f32 v40, v40
  v_exp_f32 v41, v41
  v_exp_f32 v42, v42
  v_exp_f32 v43, v43
  v_add_f32 v36, 1.0, v36
  v_add_f32 v37, 1.0, v37
  v_add_f32 v38, 1.0, v38
  v_add_f32 v39, 1.0, v39
  v_add_f32 v40, 1.0, v40
  v_add_f32 v41, 1.0, v41
  v_add_f32 v42, 1.0, v42
  v_add_f32 v43, 1.0, v43
  v_rcp_f32 v36, v36
  v_rcp_f32 v37, v37
  v_rcp_f32 v38, v38
  v_rcp_f32 v39, v39
  v_rcp_f32 v40, v40
  v_rcp_f32 v41, v41
  v_rcp_f32 v42, v42
  v_rcp_f32 v43, v43
  v_mul_f32 v120, v120, v36
  v_mul_f32 v121, v121, v37
  v_mul_f32 v122, v122, v38
  v_mul_f32 v123, v123, v39
  v_mul_f32 v124, v124, v40
  v_mul_f32 v125, v125, v41
  v_mul_f32 v126, v126, v42
  v_mul_f32 v127, v127, v43
  s_add_u32 s15, s90, 172032
  v_cvt_pk_bf16_f32 v120, v120, v121
  v_cvt_pk_bf16_f32 v121, v122, v123
  v_cvt_pk_bf16_f32 v122, v124, v125
  v_cvt_pk_bf16_f32 v123, v126, v127
  buffer_store_dwordx4 v[120:123], v5, s[72:75], s15 offen offset:1024 sc1
  ds_write_b32 v25, v26
  v_add_u32 v26, 1, v26
L_JOIN:
  s_setprio 0
  ds_read_b32 v29, v24 offset:0
  s_mov_b32 s15, 0
  ds_read_b32 v28, v24 offset:16
  s_lshl_b32 s78, s78, 13
  s_add_u32 s78, s78, s91
  s_lshl_b32 s79, s79, 13
  s_add_u32 s79, s79, s91
  s_lshl_b32 s80, s80, 13
  s_add_u32 s80, s80, s91
  s_lshl_b32 s81, s81, 13
  s_add_u32 s81, s81, s91
  s_lshl_b32 s82, s82, 13
  s_add_u32 s82, s82, s91
  s_lshl_b32 s83, s83, 13
  s_add_u32 s83, s83, s91
  s_lshl_b32 s84, s84, 13
  s_add_u32 s84, s84, s91
  s_waitcnt lgkmcnt(0)
  v_cmp_gt_u32 vcc, 6, v28
  s_cbranch_vccz L_c7d
  s_mov_b32 s68, 0
L_c7:
  ds_read_b32 v28, v24 offset:16
  s_getreg_b32 s13, hwreg(HW_REG_IB_STS)
  s_and_b32 s13, s13, 0xc0000f
  s_cmp_le_u32 s13, 0
  s_cbranch_scc0 L_c7a
  s_cmp_lg_u32 s15, 0
  s_cbranch_scc1 L_c7a
  buffer_store_dword v30, v34, s[72:75], s92 offen offset:1792 sc1
  s_mov_b32 s15, 1
L_c7a:
  s_add_u32 s68, s68, 1
  s_cmp_gt_u32 s68, 0x40000
  s_cselect_b32 s13, 0, 6
  s_waitcnt lgkmcnt(0)
  v_cmp_gt_u32 vcc, s13, v28
  s_cbranch_vccnz L_c7
L_c7d:
  s_setprio 3
  ds_read_b128 v[96:99], v89 offset:0
  ds_read_b128 v[112:115], v89 offset:4096
  ds_read_b128 v[100:103], v89 offset:1024
  ds_read_b128 v[116:119], v89 offset:5120
  ds_read_b128 v[104:107], v89 offset:2048
  ds_read_b128 v[120:123], v89 offset:6144
  ds_read_b128 v[108:111], v89 offset:3072
  ds_read_b128 v[124:127], v89 offset:7168
  ds_write_b32 v25, v26
  v_add_u32 v26, 1, v26
  s_waitcnt lgkmcnt(7)
  v_add_f32 v112, v112, v96
  v_add_f32 v113, v113, v97
  v_add_f32 v114, v114, v98
  v_add_f32 v115, v115, v99
  s_waitcnt lgkmcnt(5)
  v_add_f32 v116, v116, v100
  v_add_f32 v117, v117, v101
  v_add_f32 v118, v118, v102
  v_add_f32 v119, v119, v103
  s_waitcnt lgkmcnt(3)
  v_add_f32 v120, v120, v104
  v_add_f32 v121, v121, v105
  v_add_f32 v122, v122, v106
  v_add_f32 v123, v123, v107
  s_waitcnt lgkmcnt(1)
  v_add_f32 v124, v124, v108
  v_add_f32 v125, v125, v109
  v_add_f32 v126, v126, v110
  v_add_f32 v127, v127, v111
  v_cvt_pk_bf16_f32 v112, 0, v112
  v_cvt_pk_bf16_f32 v113, 0, v113
  v_cvt_pk_bf16_f32 v114, 0, v114
  v_cvt_pk_bf16_f32 v115, 0, v115
  v_cvt_pk_bf16_f32 v116, 0, v116
  v_cvt_pk_bf16_f32 v117, 0, v117
  v_cvt_pk_bf16_f32 v118, 0, v118
  v_cvt_pk_bf16_f32 v119, 0, v119
  v_add_f32 v112, v112, v64
  v_add_f32 v113, v113, v65
  v_add_f32 v114, v114, v66
  v_add_f32 v115, v115, v67
  v_add_f32 v116, v116, v68
  v_add_f32 v117, v117, v69
  v_add_f32 v118, v118, v70
  v_add_f32 v119, v119, v71
  v_cvt_pk_bf16_f32 v36, v112, v113
  v_cvt_pk_bf16_f32 v37, v114, v115
  v_cvt_pk_bf16_f32 v38, v116, v117
  v_cvt_pk_bf16_f32 v39, v118, v119
  s_nop 1
  v_permlane16_swap_b32 v36, v38
  v_permlane16_swap_b32 v37, v39
  buffer_store_dwordx4 v[36:39], v90, s[72:75], s95 offen offset:0 sc1
  s_load_dwordx16 s[32:47], s[72:73], s93 offset:1664 glc
  v_cvt_pk_bf16_f32 v120, 0, v120
  v_cvt_pk_bf16_f32 v121, 0, v121
  v_cvt_pk_bf16_f32 v122, 0, v122
  v_cvt_pk_bf16_f32 v123, 0, v123
  v_cvt_pk_bf16_f32 v124, 0, v124
  v_cvt_pk_bf16_f32 v125, 0, v125
  v_cvt_pk_bf16_f32 v126, 0, v126
  v_cvt_pk_bf16_f32 v127, 0, v127
  v_add_f32 v120, v120, v72
  v_add_f32 v121, v121, v73
  v_add_f32 v122, v122, v74
  v_add_f32 v123, v123, v75
  v_add_f32 v124, v124, v76
  v_add_f32 v125, v125, v77
  v_add_f32 v126, v126, v78
  v_add_f32 v127, v127, v79
  v_cvt_pk_bf16_f32 v40, v120, v121
  v_cvt_pk_bf16_f32 v41, v122, v123
  v_cvt_pk_bf16_f32 v42, v124, v125
  v_cvt_pk_bf16_f32 v43, v126, v127
  s_nop 1
  v_permlane16_swap_b32 v40, v42
  v_permlane16_swap_b32 v41, v43
  buffer_store_dwordx4 v[40:43], v90, s[72:75], s95 offen offset:1024 sc1
  s_mov_b32 s15, 0
  s_setprio 0
  s_waitcnt lgkmcnt(0)
  s_xor_b64 s[66:67], s[32:33], s[64:65]
  s_xor_b64 s[76:77], s[34:35], s[64:65]
  s_or_b64 s[66:67], s[66:67], s[76:77]
  s_xor_b64 s[76:77], s[36:37], s[64:65]
  s_or_b64 s[66:67], s[66:67], s[76:77]
  s_xor_b64 s[76:77], s[38:39], s[64:65]
  s_or_b64 s[66:67], s[66:67], s[76:77]
  s_xor_b64 s[76:77], s[40:41], s[64:65]
  s_or_b64 s[66:67], s[66:67], s[76:77]
  s_xor_b64 s[76:77], s[42:43], s[64:65]
  s_or_b64 s[66:67], s[66:67], s[76:77]
  s_xor_b64 s[76:77], s[44:45], s[64:65]
  s_or_b64 s[66:67], s[66:67], s[76:77]
  s_cbranch_scc0 L_b1d
  s_mov_b32 s68, 0
L_b1p:
  s_load_dwordx16 s[32:47], s[72:73], s93 offset:1664 glc
L_w0:
  s_getreg_b32 s13, hwreg(HW_REG_IB_STS)
  s_and_b32 s13, s13, 0xc0000f
  s_cmp_le_u32 s13, 2
  s_cbranch_scc0 L_t0
  s_cmp_lg_u32 s15, 0
  s_cbranch_scc1 L_u0
  buffer_store_dword v30, v34, s[72:75], s92 offen offset:1792 sc1
  s_mov_b32 s15, 1
  s_branch L_t0
L_u0:
  s_cmp_gt_u32 s13, 1
  s_cbranch_scc1 L_t0
  s_cmp_lg_u32 s15, 1
  s_cbranch_scc1 L_t0
  buffer_store_dword v30, v91, s[72:75], s86 offen sc1
  s_mov_b32 s15, 2
L_t0:
  s_getreg_b32 s13, hwreg(HW_REG_IB_STS, 8, 4)
  s_cmp_lg_u32 s13, 0
  s_cbranch_scc1 L_w0
  s_add_u32 s68, s68, 1
  s_cmp_gt_u32 s68, 0x20000
  s_cbranch_scc1 L_b1d
  s_xor_b64 s[66:67], s[32:33], s[64:65]
  s_xor_b64 s[76:77], s[34:35], s[64:65]
  s_or_b64 s[66:67], s[66:67], s[76:77]
  s_xor_b64 s[76:77], s[36:37], s[64:65]
  s_or_b64 s[66:67], s[66:67], s[76:77]
  s_xor_b64 s[76:77], s[38:39], s[64:65]
  s_or_b64 s[66:67], s[66:67], s[76:77]
  s_xor_b64 s[76:77], s[40:41], s[64:65]
  s_or_b64 s[66:67], s[66:67], s[76:77]
  s_xor_b64 s[76:77], s[42:43], s[64:65]
  s_or_b64 s[66:67], s[66:67], s[76:77]
  s_xor_b64 s[76:77], s[44:45], s[64:65]
  s_or_b64 s[66:67], s[66:67], s[76:77]
  s_cbranch_scc1 L_b1p
L_b1d:
  s_setprio 1
  s_waitcnt vmcnt(2)
  buffer_store_dword v30, v34, s[72:75], s92 offen offset:1792 sc1
  buffer_load_dwordx4 a[0:3], v5, s[72:75], s78 offen offset:0 sc1
  buffer_load_dwordx4 a[4:7], v5, s[72:75], s78 offen offset:2048 sc1
  buffer_load_dwordx4 a[8:11], v5, s[72:75], s79 offen offset:0 sc1
  s_waitcnt vmcnt(4)
  buffer_store_dword v30, v91, s[72:75], s86 offen sc1
  buffer_load_dwordx4 a[12:15], v5, s[72:75], s79 offen offset:2048 sc1
  buffer_load_dwordx4 a[16:19], v5, s[72:75], s80 offen offset:0 sc1
  buffer_load_dwordx4 a[20:23], v5, s[72:75], s80 offen offset:2048 sc1
  buffer_load_dwordx4 a[24:27], v5, s[72:75], s81 offen offset:0 sc1
  v_cmp_gt_u32 vcc, 20, v29
  s_cbranch_vccnz L_sp_65
L_sd_66:
  ds_read_b64_tr_b16 v[44:45], v7 offset:0
  ds_read_b64_tr_b16 v[46:47], v7 offset:1024
  ds_read_b64_tr_b16 v[48:49], v8 offset:0
  ds_read_b64_tr_b16 v[50:51], v8 offset:1024
  ds_read_b64_tr_b16 v[52:53], v7 offset:4096
  ds_read_b64_tr_b16 v[54:55], v7 offset:5120
  buffer_load_dwordx4 a[28:31], v5, s[72:75], s81 offen offset:2048 sc1
  s_waitcnt vmcnt(8) lgkmcnt(4)
  v_mfma_f32_32x32x16_bf16 v[96:111], v[44:47], a[0:3], 0
  ds_read_b64_tr_b16 v[56:57], v8 offset:4096
  ds_read_b64_tr_b16 v[58:59], v8 offset:5120
  buffer_load_dwordx4 a[32:35], v5, s[72:75], s82 offen offset:0 sc1
  s_waitcnt lgkmcnt(4)
  v_mfma_f32_32x32x16_bf16 v[112:127], v[48:51], a[0:3], 0
  ds_read_b64_tr_b16 v[60:61], v7 offset:16384
  ds_read_b64_tr_b16 v[62:63], v7 offset:17408
  s_waitcnt vmcnt(8) lgkmcnt(4)
  v_mfma_f32_32x32x16_bf16 v[96:111], v[52:55], a[4:7], v[96:111]
  ds_read_b64_tr_b16 v[36:37], v8 offset:16384
  ds_read_b64_tr_b16 v[38:39], v8 offset:17408
  s_load_dwordx16 s[16:31], s[72:73], s93 offset:1792 glc
  buffer_load_dwordx4 a[36:39], v5, s[72:75], s82 offen offset:2048 sc1
  s_waitcnt lgkmcnt(4)
  v_mfma_f32_32x32x16_bf16 v[112:127], v[56:59], a[4:7], v[112:127]
  ds_read_b64_tr_b16 v[40:41], v7 offset:20480
  ds_read_b64_tr_b16 v[42:43], v7 offset:21504
  s_waitcnt vmcnt(8) lgkmcnt(4)
  v_mfma_f32_32x32x16_bf16 v[96:111], v[60:63], a[8:11], v[96:111]
  ds_read_b64_tr_b16 v[44:45], v8 offset:20480
  ds_read_b64_tr_b16 v[46:47], v8 offset:21504
  buffer_load_dwordx4 a[40:43], v5, s[72:75], s83 offen offset:0 sc1
  s_waitcnt lgkmcnt(4)
  v_mfma_f32_32x32x16_bf16 v[112:127], v[36:39], a[8:11], v[112:127]
  ds_read_b64_tr_b16 v[48:49], v7 offset:32768
  ds_read_b64_tr_b16 v[50:51], v7 offset:33792
  s_waitcnt vmcnt(7) lgkmcnt(4)
  v_mfma_f32_32x32x16_bf16 v[96:111], v[40:43], a[12:15], v[96:111]
  ds_read_b64_tr_b16 v[52:53], v8 offset:32768
  ds_read_b64_tr_b16 v[54:55], v8 offset:33792
  buffer_load_dwordx4 a[44:47], v5, s[72:75], s83 offen offset:2048 sc1
  s_waitcnt lgkmcnt(4)
  v_mfma_f32_32x32x16_bf16 v[112:127], v[44:47], a[12:15], v[112:127]
  ds_read_b64_tr_b16 v[56:57], v7 offset:36864
  ds_read_b64_tr_b16 v[58:59], v7 offset:37888
  s_waitcnt vmcnt(7) lgkmcnt(4)
  v_mfma_f32_32x32x16_bf16 v[96:111], v[48:51], a[16:19], v[96:111]
  ds_read_b64_tr_b16 v[60:61], v8 offset:36864
  ds_read_b64_tr_b16 v[62:63], v8 offset:37888
  buffer_load_dwordx4 a[48:51], v5, s[72:75], s84 offen offset:0 sc1
  s_waitcnt lgkmcnt(4)
  v_mfma_f32_32x32x16_bf16 v[112:127], v[52:55], a[16:19], v[112:127]
  ds_read_b64_tr_b16 v[36:37], v7 offset:49152
  ds_read_b64_tr_b16 v[38:39], v7 offset:50176
  s_waitcnt vmcnt(7) lgkmcnt(4)
  v_mfma_f32_32x32x16_bf16 v[96:111], v[56:59], a[20:23], v[96:111]
  ds_read_b64_tr_b16 v[40:41], v8 offset:49152
  ds_read_b64_tr_b16 v[42:43], v8 offset:50176
  buffer_load_dwordx4 a[52:55], v5, s[72:75], s84 offen offset:2048 sc1
  s_waitcnt lgkmcnt(4)
  v_mfma_f32_32x32x16_bf16 v[112:127], v[60:63], a[20:23], v[112:127]
  ds_read_b64_tr_b16 v[44:45], v7 offset:53248
  ds_read_b64_tr_b16 v[46:47], v7 offset:54272
  s_waitcnt vmcnt(7) lgkmcnt(4)
  v_mfma_f32_32x32x16_bf16 v[96:111], v[36:39], a[24:27], v[96:111]
  ds_read_b64_tr_b16 v[48:49], v8 offset:53248
  ds_read_b64_tr_b16 v[50:51], v8 offset:54272
  s_mov_b32 s69, 1
  v_mov_b32 v21, 2.0
  s_cmp_eq_u32 s69, 0
  s_cbranch_scc1 L_rbB2_0
  s_xor_b64 s[66:67], s[16:17], s[64:65]
  s_xor_b64 s[76:77], s[18:19], s[64:65]
  s_or_b64 s[66:67], s[66:67], s[76:77]
  s_xor_b64 s[76:77], s[20:21], s[64:65]
  s_or_b64 s[66:67], s[66:67], s[76:77]
  s_xor_b64 s[76:77], s[22:23], s[64:65]
  s_or_b64 s[66:67], s[66:67], s[76:77]
  s_xor_b64 s[76:77], s[24:25], s[64:65]
  s_or_b64 s[66:67], s[66:67], s[76:77]
  s_xor_b64 s[76:77], s[26:27], s[64:65]
  s_or_b64 s[66:67], s[66:67], s[76:77]
  s_xor_b64 s[76:77], s[28:29], s[64:65]
  s_or_b64 s[66:67], s[66:67], s[76:77]
  s_cbranch_scc0 L_rgB2_0
  s_load_dwordx16 s[16:31], s[72:73], s93 offset:1792 glc
  s_branch L_rbB2_0
L_rgB2_0:
  s_mov_b32 s69, 0
  v_mov_b32 v21, v5
L_rbB2_0:
  buffer_load_dwordx4 a[56:59], v21, s[72:75], s78 offen offset:1024 sc1
  s_waitcnt lgkmcnt(4)
  v_mfma_f32_32x32x16_bf16 v[112:127], v[40:43], a[24:27], v[112:127]
  ds_read_b64_tr_b16 v[52:53], v9 offset:32768
  ds_read_b64_tr_b16 v[54:55], v9 offset:33792
  s_waitcnt vmcnt(7) lgkmcnt(4)
  v_mfma_f32_32x32x16_bf16 v[96:111], v[44:47], a[28:31], v[96:111]
  ds_read_b64_tr_b16 v[56:57], v10 offset:32768
  ds_read_b64_tr_b16 v[58:59], v10 offset:33792
  buffer_load_dwordx4 a[60:63], v21, s[72:75], s78 offen offset:3072 sc1
  s_waitcnt lgkmcnt(4)
  v_mfma_f32_32x32x16_bf16 v[112:127], v[48:51], a[28:31], v[112:127]
  ds_read_b64_tr_b16 v[60:61], v9 offset:36864
  ds_read_b64_tr_b16 v[62:63], v9 offset:37888
  s_waitcnt vmcnt(7) lgkmcnt(4)
  v_mfma_f32_32x32x16_bf16 v[96:111], v[52:55], a[32:35], v[96:111]
  ds_read_b64_tr_b16 v[36:37], v10 offset:36864
  ds_read_b64_tr_b16 v[38:39], v10 offset:37888
  s_cmp_eq_u32 s69, 0
  s_cbranch_scc1 L_rbB2_1
  s_xor_b64 s[66:67], s[16:17], s[64:65]
  s_xor_b64 s[76:77], s[18:19], s[64:65]
  s_or_b64 s[66:67], s[66:67], s[76:77]
  s_xor_b64 s[76:77], s[20:21], s[64:65]
  s_or_b64 s[66:67], s[66:67], s[76:77]
  s_xor_b64 s[76:77], s[22:23], s[64:65]
  s_or_b64 s[66:67], s[66:67], s[76:77]
  s_xor_b64 s[76:77], s[24:25], s[64:65]
  s_or_b64 s[66:67], s[66:67], s[76:77]
  s_xor_b64 s[76:77], s[26:27], s[64:65]
  s_or_b64 s[66:67], s[66:67], s[76:77]
  s_xor_b64 s[76:77], s[28:29], s[64:65]
  s_or_b64 s[66:67], s[66:67], s[76:77]
  s_cbranch_scc0 L_rgB2_1
  s_load_dwordx16 s[16:31], s[72:73], s93 offset:1792 glc
  s_branch L_rbB2_1
L_rgB2_1:
  buffer_load_dwordx4 a[56:59], v5, s[72:75], s78 offen offset:1024 sc1
  buffer_load_dwordx4 a[60:63], v5, s[72:75], s78 offen offset:3072 sc1
  s_mov_b32 s69, 0
  v_mov_b32 v21, v5
L_rbB2_1:
  buffer_load_dwordx4 a[64:67], v21, s[72:75], s79 offen offset:1024 sc1
  s_waitcnt lgkmcnt(4)
  v_mfma_f32_32x32x16_bf16 v[112:127], v[56:59], a[32:35], v[112:127]
  ds_read_b64_tr_b16 v[40:41], v9 offset:0
  ds_read_b64_tr_b16 v[42:43], v9 offset:1024
  s_add_u32 s13, s88, 123904
  v_add_u32 v11, s13, v5
  s_xor_b32 s13, s88, 8192
  s_add_u32 s13, s13, 123904
  v_add_u32 v12, s13, v5
  s_waitcnt vmcnt(7) lgkmcnt(4)
  v_mfma_f32_32x32x16_bf16 v[96:111], v[60:63], a[36:39], v[96:111]
  ds_read_b64_tr_b16 v[44:45], v10 offset:0
  ds_read_b64_tr_b16 v[46:47], v10 offset:1024
  buffer_load_dwordx4 a[68:71], v21, s[72:75], s79 offen offset:3072 sc1
  s_waitcnt lgkmcnt(4)
  v_mfma_f32_32x32x16_bf16 v[112:127], v[36:39], a[36:39], v[112:127]
  ds_read_b64_tr_b16 v[48:49], v9 offset:4096
  ds_read_b64_tr_b16 v[50:51], v9 offset:5120
  v_and_b32 v1, 31, v4
  v_lshrrev_b32 v2, 5, v4
  v_bfe_u32 v32, v4, 2, 2
  v_lshlrev_b32 v32, 4, v32
  s_waitcnt vmcnt(7) lgkmcnt(4)
  v_mfma_f32_32x32x16_bf16 v[96:111], v[40:43], a[40:43], v[96:111]
  ds_read_b64_tr_b16 v[52:53], v10 offset:4096
  ds_read_b64_tr_b16 v[54:55], v10 offset:5120
  s_cmp_eq_u32 s69, 0
  s_cbranch_scc1 L_rbB2_2
  s_xor_b64 s[66:67], s[16:17], s[64:65]
  s_xor_b64 s[76:77], s[18:19], s[64:65]
  s_or_b64 s[66:67], s[66:67], s[76:77]
  s_xor_b64 s[76:77], s[20:21], s[64:65]
  s_or_b64 s[66:67], s[66:67], s[76:77]
  s_xor_b64 s[76:77], s[22:23], s[64:65]
  s_or_b64 s[66:67], s[66:67], s[76:77]
  s_xor_b64 s[76:77], s[24:25], s[64:65]
  s_or_b64 s[66:67], s[66:67], s[76:77]
  s_xor_b64 s[76:77], s[26:27], s[64:65]
  s_or_b64 s[66:67], s[66:67], s[76:77]
  s_xor_b64 s[76:77], s[28:29], s[64:65]
  s_or_b64 s[66:67], s[66:67], s[76:77]
  s_cbranch_scc0 L_rgB2_2
  s_load_dwordx16 s[16:31], s[72:73], s93 offset:1792 glc
  s_branch L_rbB2_2
L_rgB2_2:
  buffer_load_dwordx4 a[56:59], v5, s[72:75], s78 offen offset:1024 sc1
  buffer_load_dwordx4 a[60:63], v5, s[72:75], s78 offen offset:3072 sc1
  buffer_load_dwordx4 a[64:67], v5, s[72:75], s79 offen offset:1024 sc1
  buffer_load_dwordx4 a[68:71], v5, s[72:75], s79 offen offset:3072 sc1
  s_mov_b32 s69, 0
  v_mov_b32 v21, v5
L_rbB2_2:
  buffer_load_dwordx4 a[72:75], v21, s[72:75], s80 offen offset:1024 sc1
  s_waitcnt lgkmcnt(4)
  v_mfma_f32_32x32x16_bf16 v[112:127], v[44:47], a[40:43], v[112:127]
  ds_read_b64_tr_b16 v[56:57], v9 offset:16384
  ds_read_b64_tr_b16 v[58:59], v9 offset:17408
  v_lshl_add_u32 v32, v2, 3, v32
  v_lshl_add_u32 v32, v1, 6, v32
  v_add_u32 v17, s13, v32
  v_lshrrev_b32 v1, 2, v4
  s_waitcnt vmcnt(7) lgkmcnt(4)
  v_mfma_f32_32x32x16_bf16 v[96:111], v[48:51], a[44:47], v[96:111]
  ds_read_b64_tr_b16 v[60:61], v10 offset:16384
  ds_read_b64_tr_b16 v[62:63], v10 offset:17408
  buffer_load_dwordx4 a[76:79], v21, s[72:75], s80 offen offset:3072 sc1
  s_add_u32 s94, s96, 4096
  s_load_dwordx2 s[70:71], s[72:73], s97 offset:0 glc
  s_mov_b32 s85, 1
  v_mov_b32 v22, 2.0
  s_waitcnt lgkmcnt(4)
  v_mfma_f32_32x32x16_bf16 v[112:127], v[52:55], a[44:47], v[112:127]
  ds_read_b64_tr_b16 v[36:37], v9 offset:20480
  ds_read_b64_tr_b16 v[38:39], v9 offset:21504
  v_and_b32 v2, 3, v4
  v_lshlrev_b32 v32, 4, v2
  v_lshl_add_u32 v19, v1, 10, v32
  v_lshrrev_b32 v32, 4, v4
  s_waitcnt vmcnt(7) lgkmcnt(4)
  v_mfma_f32_32x32x16_bf16 v[96:111], v[56:59], a[48:51], v[96:111]
  ds_read_b64_tr_b16 v[40:41], v10 offset:20480
  ds_read_b64_tr_b16 v[42:43], v10 offset:21504
  s_cmp_eq_u32 s69, 0
  s_cbranch_scc1 L_rbB2_3
  s_xor_b64 s[66:67], s[16:17], s[64:65]
  s_xor_b64 s[76:77], s[18:19], s[64:65]
  s_or_b64 s[66:67], s[66:67], s[76:77]
  s_xor_b64 s[76:77], s[20:21], s[64:65]
  s_or_b64 s[66:67], s[66:67], s[76:77]
  s_xor_b64 s[76:77], s[22:23], s[64:65]
  s_or_b64 s[66:67], s[66:67], s[76:77]
  s_xor_b64 s[76:77], s[24:25], s[64:65]
  s_or_b64 s[66:67], s[66:67], s[76:77]
  s_xor_b64 s[76:77], s[26:27], s[64:65]
  s_or_b64 s[66:67], s[66:67], s[76:77]
  s_xor_b64 s[76:77], s[28:29], s[64:65]
  s_or_b64 s[66:67], s[66:67], s[76:77]
  s_cbranch_scc1 L_rpB2_3
L_rgB2_3:
  buffer_load_dwordx4 a[56:59], v5, s[72:75], s78 offen offset:1024 sc1
  buffer_load_dwordx4 a[60:63], v5, s[72:75], s78 offen offset:3072 sc1
  buffer_load_dwordx4 a[64:67], v5, s[72:75], s79 offen offset:1024 sc1
  buffer_load_dwordx4 a[68:71], v5, s[72:75], s79 offen offset:3072 sc1
  buffer_load_dwordx4 a[72:75], v5, s[72:75], s80 offen offset:1024 sc1
  buffer_load_dwordx4 a[76:79], v5, s[72:75], s80 offen offset:3072 sc1
  s_mov_b32 s69, 0
  v_mov_b32 v21, v5
L_rbB2_3:
  buffer_load_dwordx4 a[80:83], v21, s[72:75], s81 offen offset:1024 sc1
  s_waitcnt lgkmcnt(4)
  v_mfma_f32_32x32x16_bf16 v[112:127], v[60:63], a[48:51], v[112:127]
  ds_read_b64_tr_b16 v[44:45], v7 offset:2048
  ds_read_b64_tr_b16 v[46:47], v7 offset:3072
  v_xor_b32 v2, v2, v32
  v_lshlrev_b32 v2, 4, v2
  v_lshl_add_u32 v2, v1, 6, v2
  v_add_u32 v18, s13, v2
  s_waitcnt vmcnt(7) lgkmcnt(4)
  v_mfma_f32_32x32x16_bf16 v[96:111], v[36:39], a[52:55], v[96:111]
  ds_read_b64_tr_b16 v[48:49], v8 offset:2048
  ds_read_b64_tr_b16 v[50:51], v8 offset:3072
  buffer_load_dwordx4 a[84:87], v21, s[72:75], s81 offen offset:3072 sc1
  s_waitcnt lgkmcnt(4)
  v_mfma_f32_32x32x16_bf16 v[112:127], v[40:43], a[52:55], v[112:127]
  ds_read_b64_tr_b16 v[52:53], v7 offset:6144
  ds_read_b64_tr_b16 v[54:55], v7 offset:7168
  s_mul_i32 s13, s6, 2304
  s_add_u32 s13, s13, 114688
  v_add_u32 v20, s13, v5
  v_lshrrev_b32 v1, 2, v5
  v_add_u32 v1, s13, v1
  s_waitcnt vmcnt(7) lgkmcnt(4)
  v_mfma_f32_32x32x16_bf16 v[96:111], v[44:47], a[56:59], v[96:111]
  ds_read_b64_tr_b16 v[56:57], v8 offset:6144
  ds_read_b64_tr_b16 v[58:59], v8 offset:7168
  buffer_load_dwordx4 a[88:91], v21, s[72:75], s82 offen offset:1024 sc1
  s_waitcnt lgkmcnt(4)
  v_mfma_f32_32x32x16_bf16 v[112:127], v[48:51], a[56:59], v[112:127]
  ds_read_b64_tr_b16 v[60:61], v7 offset:18432
  ds_read_b64_tr_b16 v[62:63], v7 offset:19456
  s_waitcnt vmcnt(7) lgkmcnt(4)
  v_mfma_f32_32x32x16_bf16 v[96:111], v[52:55], a[60:63], v[96:111]
  ds_read_b64_tr_b16 v[36:37], v8 offset:18432
  ds_read_b64_tr_b16 v[38:39], v8 offset:19456
  buffer_load_dwordx4 a[92:95], v21, s[72:75], s82 offen offset:3072 sc1
  s_waitcnt lgkmcnt(4)
  v_mfma_f32_32x32x16_bf16 v[112:127], v[56:59], a[60:63], v[112:127]
  ds_read_b64_tr_b16 v[40:41], v7 offset:22528
  ds_read_b64_tr_b16 v[42:43], v7 offset:23552
  s_waitcnt vmcnt(7) lgkmcnt(4)
  v_mfma_f32_32x32x16_bf16 v[96:111], v[60:63], a[64:67], v[96:111]
  ds_read_b64_tr_b16 v[44:45], v8 offset:22528
  ds_read_b64_tr_b16 v[46:47], v8 offset:23552
  buffer_load_dwordx4 a[96:99], v21, s[72:75], s83 offen offset:1024 sc1
  s_waitcnt lgkmcnt(4)
  v_mfma_f32_32x32x16_bf16 v[112:127], v[36:39], a[64:67], v[112:127]
  ds_read_b64_tr_b16 v[48:49], v7 offset:34816
  ds_read_b64_tr_b16 v[50:51], v7 offset:35840
  s_waitcnt vmcnt(7) lgkmcnt(4)
  v_mfma_f32_32x32x16_bf16 v[96:111], v[40:43], a[68:71], v[96:111]
  ds_read_b64_tr_b16 v[52:53], v8 offset:34816
  ds_read_b64_tr_b16 v[54:55], v8 offset:35840
  buffer_load_dwordx4 a[100:103], v21, s[72:75], s83 offen offset:3072 sc1
  s_waitcnt lgkmcnt(4)
  v_mfma_f32_32x32x16_bf16 v[112:127], v[44:47], a[68:71], v[112:127]
  ds_read_b64_tr_b16 v[56:57], v7 offset:38912
  ds_read_b64_tr_b16 v[58:59], v7 offset:39936
  s_waitcnt vmcnt(7) lgkmcnt(4)
  v_mfma_f32_32x32x16_bf16 v[96:111], v[48:51], a[72:75], v[96:111]
  ds_read_b64_tr_b16 v[60:61], v8 offset:38912
  ds_read_b64_tr_b16 v[62:63], v8 offset:39936
  buffer_load_dwordx4 a[104:107], v21, s[72:75], s84 offen offset:1024 sc1
  s_waitcnt lgkmcnt(4)
  v_mfma_f32_32x32x16_bf16 v[112:127], v[52:55], a[72:75], v[112:127]
  ds_read_b64_tr_b16 v[36:37], v7 offset:51200
  ds_read_b64_tr_b16 v[38:39], v7 offset:52224
  s_waitcnt vmcnt(7) lgkmcnt(4)
  v_mfma_f32_32x32x16_bf16 v[96:111], v[56:59], a[76:79], v[96:111]
  ds_read_b64_tr_b16 v[40:41], v8 offset:51200
  ds_read_b64_tr_b16 v[42:43], v8 offset:52224
  buffer_load_dwordx4 a[108:111], v21, s[72:75], s84 offen offset:3072 sc1
  s_cmp_eq_u32 s85, 0
  s_cbranch_scc1 L_rbP_4
  s_xor_b64 s[66:67], s[70:71], s[64:65]
  s_cbranch_scc0 L_rgP_4
  s_load_dwordx2 s[70:71], s[72:73], s97 offset:0 glc
  s_branch L_rbP_4
L_rgP_4:
  s_mov_b32 s85, 0
  v_mov_b32 v22, v5
L_rbP_4:
  buffer_load_dwordx4 v[64:67], v22, s[72:75], s96 offen offset:0 sc1
  buffer_load_dwordx4 v[68:71], v22, s[72:75], s96 offen offset:1024 sc1
  buffer_load_dwordx4 v[72:75], v22, s[72:75], s96 offen offset:2048 sc1
  buffer_load_dwordx4 v[76:79], v22, s[72:75], s96 offen offset:3072 sc1
  s_waitcnt lgkmcnt(4)
  v_mfma_f32_32x32x16_bf16 v[112:127], v[60:63], a[76:79], v[112:127]
  ds_read_b64_tr_b16 v[44:45], v7 offset:55296
  ds_read_b64_tr_b16 v[46:47], v7 offset:56320
  s_waitcnt vmcnt(11) lgkmcnt(4)
  v_mfma_f32_32x32x16_bf16 v[96:111], v[36:39], a[80:83], v[96:111]
  ds_read_b64_tr_b16 v[48:49], v8 offset:55296
  ds_read_b64_tr_b16 v[50:51], v8 offset:56320
  s_waitcnt lgkmcnt(4)
  v_mfma_f32_32x32x16_bf16 v[112:127], v[40:43], a[80:83], v[112:127]
  ds_read_b64_tr_b16 v[52:53], v9 offset:34816
  ds_read_b64_tr_b16 v[54:55], v9 offset:35840
  s_waitcnt vmcnt(10) lgkmcnt(4)
  v_mfma_f32_32x32x16_bf16 v[96:111], v[44:47], a[84:87], v[96:111]
  ds_read_b64_tr_b16 v[56:57], v10 offset:34816
  ds_read_b64_tr_b16 v[58:59], v10 offset:35840
  s_waitcnt lgkmcnt(4)
  v_mfma_f32_32x32x16_bf16 v[112:127], v[48:51], a[84:87], v[112:127]
  ds_read_b64_tr_b16 v[60:61], v10 offset:38912
  ds_read_b64_tr_b16 v[62:63], v10 offset:39936
  s_waitcnt vmcnt(9) lgkmcnt(4)
  v_mfma_f32_32x32x16_bf16 v[96:111], v[52:55], a[88:91], v[96:111]
  ds_read_b64_tr_b16 v[36:37], v10 offset:2048
  ds_read_b64_tr_b16 v[38:39], v10 offset:3072
  s_cmp_eq_u32 s85, 0
  s_cbranch_scc1 L_rbP_5
  s_xor_b64 s[66:67], s[70:71], s[64:65]
  s_cbranch_scc0 L_rgP_5
  s_load_dwordx2 s[70:71], s[72:73], s97 offset:0 glc
  s_branch L_rbP_5
L_rgP_5:
  buffer_load_dwordx4 v[64:67], v5, s[72:75], s96 offen offset:0 sc1
  buffer_load_dwordx4 v[68:71], v5, s[72:75], s96 offen offset:1024 sc1
  buffer_load_dwordx4 v[72:75], v5, s[72:75], s96 offen offset:2048 sc1
  buffer_load_dwordx4 v[76:79], v5, s[72:75], s96 offen offset:3072 sc1
  s_mov_b32 s85, 0
  v_mov_b32 v22, v5
L_rbP_5:
  s_waitcnt lgkmcnt(4)
  v_mfma_f32_32x32x16_bf16 v[112:127], v[56:59], a[88:91], v[112:127]
  ds_read_b64_tr_b16 v[40:41], v10 offset:6144
  ds_read_b64_tr_b16 v[42:43], v10 offset:7168
  s_waitcnt vmcnt(8) lgkmcnt(4)
  v_mfma_f32_32x32x16_bf16 v[112:127], v[60:63], a[92:95], v[112:127]
  ds_read_b64_tr_b16 v[44:45], v10 offset:18432
  ds_read_b64_tr_b16 v[46:47], v10 offset:19456
  s_waitcnt vmcnt(7) lgkmcnt(4)
  v_mfma_f32_32x32x16_bf16 v[112:127], v[36:39], a[96:99], v[112:127]
  ds_read_b64_tr_b16 v[48:49], v10 offset:22528
  ds_read_b64_tr_b16 v[50:51], v10 offset:23552
  ds_read_b32 v28, v24 offset:16
  s_waitcnt vmcnt(6) lgkmcnt(5)
  v_mfma_f32_32x32x16_bf16 v[112:127], v[40:43], a[100:103], v[112:127]
  ds_read_b64_tr_b16 v[52:53], v9 offset:38912
  ds_read_b64_tr_b16 v[54:55], v9 offset:39936
  s_waitcnt vmcnt(5) lgkmcnt(5)
  v_mfma_f32_32x32x16_bf16 v[112:127], v[44:47], a[104:107], v[112:127]
  ds_read_b64_tr_b16 v[56:57], v9 offset:2048
  ds_read_b64_tr_b16 v[58:59], v9 offset:3072
  s_waitcnt vmcnt(4) lgkmcnt(5)
  v_mfma_f32_32x32x16_bf16 v[112:127], v[48:51], a[108:111], v[112:127]
  ds_read_b64_tr_b16 v[60:61], v9 offset:6144
  ds_read_b64_tr_b16 v[62:63], v9 offset:7168
  s_cmp_eq_u32 s85, 0
  s_cbranch_scc1 L_rbP_6
  s_xor_b64 s[66:67], s[70:71], s[64:65]
  s_cbranch_scc0 L_rgP_6
  s_load_dwordx2 s[70:71], s[72:73], s97 offset:0 glc
  s_branch L_rbP_6
L_rgP_6:
  buffer_load_dwordx4 v[64:67], v5, s[72:75], s96 offen offset:0 sc1
  buffer_load_dwordx4 v[68:71], v5, s[72:75], s96 offen offset:1024 sc1
  buffer_load_dwordx4 v[72:75], v5, s[72:75], s96 offen offset:2048 sc1
  buffer_load_dwordx4 v[76:79], v5, s[72:75], s96 offen offset:3072 sc1
  s_mov_b32 s85, 0
  v_mov_b32 v22, v5
L_rbP_6:
  s_waitcnt lgkmcnt(6)
  v_cmp_gt_u32 vcc, 9, v28
  s_cbranch_vccnz L_sp_68
L_sd_69:
  s_waitcnt lgkmcnt(4)
  v_mfma_f32_32x32x16_bf16 v[96:111], v[52:55], a[92:95], v[96:111]
  ds_read_b64_tr_b16 v[36:37], v9 offset:18432
  ds_read_b64_tr_b16 v[38:39], v9 offset:19456
  s_waitcnt lgkmcnt(4)
  v_mfma_f32_32x32x16_bf16 v[96:111], v[56:59], a[96:99], v[96:111]
  ds_read_b64_tr_b16 v[40:41], v9 offset:22528
  ds_read_b64_tr_b16 v[42:43], v9 offset:23552
  ds_write_b128 v11, v[112:115] offset:0
  ds_write_b128 v11, v[116:119] offset:1024
  ds_write_b128 v11, v[120:123] offset:2048
  ds_write_b128 v11, v[124:127] offset:3072
  ds_write_b32 v25, v26
  v_add_u32 v26, 1, v26
  s_waitcnt lgkmcnt(9)
  v_mfma_f32_32x32x16_bf16 v[96:111], v[60:63], a[100:103], v[96:111]
  ds_read_b32 v29, v25 offset:32
  ds_read_b128 v[44:47], v20
  ds_read_b128 v[48:51], v20 offset:1024
  ds_read_b32 v52, v1 offset:2048
  s_waitcnt lgkmcnt(11)
  v_mfma_f32_32x32x16_bf16 v[96:111], v[36:39], a[104:107], v[96:111]
  s_waitcnt lgkmcnt(9)
  v_mfma_f32_32x32x16_bf16 v[96:111], v[40:43], a[108:111], v[96:111]
  ds_read_b32 v28, v24 offset:0
  ds_read_b128 v[112:115], v12 offset:0
  ds_read_b128 v[116:119], v12 offset:1024
  ds_read_b128 v[120:123], v12 offset:2048
  ds_read_b128 v[124:127], v12 offset:3072
  s_setprio 1
  s_cmp_eq_u32 s85, 0
  s_cbranch_scc1 L_rbP_7
  s_xor_b64 s[66:67], s[70:71], s[64:65]
  s_cbranch_scc1 L_rpP_7
L_rgP_7:
  buffer_load_dwordx4 v[64:67], v5, s[72:75], s96 offen offset:0 sc1
  buffer_load_dwordx4 v[68:71], v5, s[72:75], s96 offen offset:1024 sc1
  buffer_load_dwordx4 v[72:75], v5, s[72:75], s96 offen offset:2048 sc1
  buffer_load_dwordx4 v[76:79], v5, s[72:75], s96 offen offset:3072 sc1
  s_mov_b32 s85, 0
  v_mov_b32 v22, v5
L_rbP_7:
  s_waitcnt lgkmcnt(8)
  v_cmp_gt_u32 vcc, 64, v29
  s_cbranch_vccnz L_sp_71
L_sd_72:
  s_waitcnt lgkmcnt(5)
  v_mov_b32 v53, v52
  v_lshlrev_b32 v80, 16, v44
  v_and_b32 v81, s0, v44
  v_lshlrev_b32 v82, 16, v45
  v_and_b32 v83, s0, v45
  v_lshlrev_b32 v84, 16, v46
  v_and_b32 v85, s0, v46
  v_lshlrev_b32 v86, 16, v47
  v_and_b32 v87, s0, v47
  v_lshlrev_b32 v88, 16, v48
  v_and_b32 v89, s0, v48
  v_lshlrev_b32 v90, 16, v49
  v_and_b32 v91, s0, v49
  v_lshlrev_b32 v92, 16, v50
  v_and_b32 v93, s0, v50
  v_lshlrev_b32 v94, 16, v51
  v_and_b32 v95, s0, v51
  s_waitcnt lgkmcnt(4)
  v_cmp_gt_u32 vcc, 22, v28
  s_cbranch_vccnz L_sp_74
L_sd_75:
  s_waitcnt lgkmcnt(3) vmcnt(3)
  v_pk_add_f32 v[64:65], v[64:65], v[112:113]
  v_pk_add_f32 v[66:67], v[66:67], v[114:115]
  s_waitcnt lgkmcnt(2) vmcnt(2)
  v_pk_add_f32 v[68:69], v[68:69], v[116:117]
  v_pk_add_f32 v[70:71], v[70:71], v[118:119]
  s_waitcnt lgkmcnt(1) vmcnt(1)
  v_pk_add_f32 v[72:73], v[72:73], v[120:121]
  v_pk_add_f32 v[74:75], v[74:75], v[122:123]
  s_waitcnt lgkmcnt(0) vmcnt(0)
  v_pk_add_f32 v[76:77], v[76:77], v[124:125]
  v_pk_add_f32 v[78:79], v[78:79], v[126:127]
  v_pk_add_f32 v[96:97], v[96:97], v[64:65]
  v_pk_add_f32 v[98:99], v[98:99], v[66:67]
  v_cvt_pk_bf16_f32 v96, 0, v96
  v_cvt_pk_bf16_f32 v97, 0, v97
  v_cvt_pk_bf16_f32 v98, 0, v98
  v_cvt_pk_bf16_f32 v99, 0, v99
  v_pk_mul_f32 v[96:97], v[96:97], v[52:53]
  v_pk_mul_f32 v[98:99], v[98:99], v[52:53]
  v_cvt_pk_bf16_f32 v96, 0, v96
  v_cvt_pk_bf16_f32 v97, 0, v97
  v_cvt_pk_bf16_f32 v98, 0, v98
  v_cvt_pk_bf16_f32 v99, 0, v99
  v_pk_add_f32 v[96:97], v[96:97], v[80:81]
  v_pk_add_f32 v[98:99], v[98:99], v[82:83]
  v_cvt_pk_bf16_f32 v96, v96, v97
  v_cvt_pk_bf16_f32 v97, v98, v99
  ds_write_b64 v17, v[96:97]
  v_pk_add_f32 v[100:101], v[100:101], v[68:69]
  v_pk_add_f32 v[102:103], v[102:103], v[70:71]
  v_cvt_pk_bf16_f32 v100, 0, v100
  v_cvt_pk_bf16_f32 v101, 0, v101
  v_cvt_pk_bf16_f32 v102, 0, v102
  v_cvt_pk_bf16_f32 v103, 0, v103
  v_pk_mul_f32 v[100:101], v[100:101], v[52:53]
  v_pk_mul_f32 v[102:103], v[102:103], v[52:53]
  v_cvt_pk_bf16_f32 v100, 0, v100
  v_cvt_pk_bf16_f32 v101, 0, v101
  v_cvt_pk_bf16_f32 v102, 0, v102
  v_cvt_pk_bf16_f32 v103, 0, v103
  v_pk_add_f32 v[100:101], v[100:101], v[84:85]
  v_pk_add_f32 v[102:103], v[102:103], v[86:87]
  v_cvt_pk_bf16_f32 v100, v100, v101
  v_cvt_pk_bf16_f32 v101, v102, v103
  v_xor_b32 v1, 16, v17
  ds_write_b64 v1, v[100:101]
  v_pk_add_f32 v[104:105], v[104:105], v[72:73]
  v_pk_add_f32 v[106:107], v[106:107], v[74:75]
  v_cvt_pk_bf16_f32 v104, 0, v104
  v_cvt_pk_bf16_f32 v105, 0, v105
  v_cvt_pk_bf16_f32 v106, 0, v106
  v_cvt_pk_bf16_f32 v107, 0, v107
  v_pk_mul_f32 v[104:105], v[104:105], v[52:53]
  v_pk_mul_f32 v[106:107], v[106:107], v[52:53]
  v_cvt_pk_bf16_f32 v104, 0, v104
  v_cvt_pk_bf16_f32 v105, 0, v105
  v_cvt_pk_bf16_f32 v106, 0, v106
  v_cvt_pk_bf16_f32 v107, 0, v107
  v_pk_add_f32 v[104:105], v[104:105], v[88:89]
  v_pk_add_f32 v[106:107], v[106:107], v[90:91]
  v_cvt_pk_bf16_f32 v104, v104, v105
  v_cvt_pk_bf16_f32 v105, v106, v107
  v_xor_b32 v1, 32, v17
  ds_write_b64 v1, v[104:105]
  v_pk_add_f32 v[108:109], v[108:109], v[76:77]
  v_pk_add_f32 v[110:111], v[110:111], v[78:79]
  v_cvt_pk_bf16_f32 v108, 0, v108
  v_cvt_pk_bf16_f32 v109, 0, v109
  v_cvt_pk_bf16_f32 v110, 0, v110
  v_cvt_pk_bf16_f32 v111, 0, v111
  v_pk_mul_f32 v[108:109], v[108:109], v[52:53]
  v_pk_mul_f32 v[110:111], v[110:111], v[52:53]
  v_cvt_pk_bf16_f32 v108, 0, v108
  v_cvt_pk_bf16_f32 v109, 0, v109
  v_cvt_pk_bf16_f32 v110, 0, v110
  v_cvt_pk_bf16_f32 v111, 0, v111
  v_pk_add_f32 v[108:109], v[108:109], v[92:93]
  v_pk_add_f32 v[110:111], v[110:111], v[94:95]
  v_cvt_pk_bf16_f32 v108, v108, v109
  v_cvt_pk_bf16_f32 v109, v110, v111
  v_xor_b32 v1, 48, v17
  ds_write_b64 v1, v[108:109]
  ds_read_b128 v[64:67], v18 offset:0
  ds_read_b128 v[68:71], v18 offset:1024
  s_add_u32 s14, s98, 16384
  s_waitcnt lgkmcnt(1)
  buffer_store_dwordx4 v[64:67], v19, s[60:63], s98 offen sc1
  s_waitcnt lgkmcnt(0)
  buffer_store_dwordx4 v[68:71], v19, s[60:63], s14 offen sc1
  s_endpgm
L_FREE:
  v_mov_b32 v26, 20
  s_lshl_b32 s4, s78, 17
  s_add_u32 m0, s88, 0
  s_add_u32 s4, s4, s87
  buffer_load_dwordx4 v13, s[56:59], s4 offen offset:0 lds
  buffer_load_dwordx4 v14, s[56:59], s4 offen offset:1024 lds
  buffer_load_dwordx4 v15, s[56:59], s4 offen offset:2048 lds
  buffer_load_dwordx4 v16, s[56:59], s4 offen offset:3072 lds
  s_lshl_b32 s4, s79, 17
  s_add_u32 m0, s88, 16384
  s_add_u32 s4, s4, s87
  buffer_load_dwordx4 v13, s[56:59], s4 offen offset:0 lds
  buffer_load_dwordx4 v14, s[56:59], s4 offen offset:1024 lds
  buffer_load_dwordx4 v15, s[56:59], s4 offen offset:2048 lds
  buffer_load_dwordx4 v16, s[56:59], s4 offen offset:3072 lds
  s_lshl_b32 s4, s80, 17
  s_add_u32 m0, s88, 32768
  s_add_u32 s4, s4, s87
  buffer_load_dwordx4 v13, s[56:59], s4 offen offset:0 lds
  buffer_load_dwordx4 v14, s[56:59], s4 offen offset:1024 lds
  buffer_load_dwordx4 v15, s[56:59], s4 offen offset:2048 lds
  buffer_load_dwordx4 v16, s[56:59], s4 offen offset:3072 lds
  s_waitcnt vmcnt(8)
  s_lshl_b32 s4, s81, 17
  s_add_u32 m0, s88, 49152
  s_add_u32 s4, s4, s87
  buffer_load_dwordx4 v13, s[56:59], s4 offen offset:0 lds
  buffer_load_dwordx4 v14, s[56:59], s4 offen offset:1024 lds
  buffer_load_dwordx4 v15, s[56:59], s4 offen offset:2048 lds
  buffer_load_dwordx4 v16, s[56:59], s4 offen offset:3072 lds
  s_waitcnt vmcnt(8)
  s_lshl_b32 s4, s82, 17
  s_add_u32 m0, s88, 98304
  s_add_u32 s4, s4, s87
  buffer_load_dwordx4 v13, s[56:59], s4 offen offset:0 lds
  buffer_load_dwordx4 v14, s[56:59], s4 offen offset:1024 lds
  buffer_load_dwordx4 v15, s[56:59], s4 offen offset:2048 lds
  buffer_load_dwordx4 v16, s[56:59], s4 offen offset:3072 lds
  s_waitcnt vmcnt(8)
  s_lshl_b32 s4, s83, 17
  s_add_u32 m0, s88, 65536
  s_add_u32 s4, s4, s87
  buffer_load_dwordx4 v13, s[56:59], s4 offen offset:0 lds
  buffer_load_dwordx4 v14, s[56:59], s4 offen offset:1024 lds
  buffer_load_dwordx4 v15, s[56:59], s4 offen offset:2048 lds
  buffer_load_dwordx4 v16, s[56:59], s4 offen offset:3072 lds
  s_waitcnt vmcnt(8)
  s_lshl_b32 s4, s84, 17
  s_add_u32 m0, s88, 81920
  s_add_u32 s4, s4, s87
  buffer_load_dwordx4 v13, s[56:59], s4 offen offset:0 lds
  buffer_load_dwordx4 v14, s[56:59], s4 offen offset:1024 lds
  buffer_load_dwordx4 v15, s[56:59], s4 offen offset:2048 lds
  buffer_load_dwordx4 v16, s[56:59], s4 offen offset:3072 lds
  s_waitcnt vmcnt(8)
  v_mov_b32 v35, 163632
  ds_read_b64 v[30:31], v35
  s_waitcnt lgkmcnt(0)
  v_cmp_eq_u32 vcc, 0, v30
  s_cbranch_vccnz L_np_77
L_nd_78:
  v_readfirstlane_b32 s64, v30
  v_readfirstlane_b32 s65, v31
  ds_read_b32 v28, v24 offset:16
  s_waitcnt lgkmcnt(0)
  v_cmp_gt_u32 vcc, 5, v28
  s_cbranch_vccnz L_sp_81
L_sd_82:
  s_waitcnt lgkmcnt(0)
  ds_read_b32 v29, v24 offset:16
  v_and_b32 v93, 15, v4
  v_lshrrev_b32 v94, 4, v4
  v_lshl_add_u32 v88, v93, 2, v94
  v_lshlrev_b32 v88, 3, v88
  s_mul_i32 s95, s43, 4608
  s_lshl_b32 s86, s42, 11
  s_sub_u32 s95, s95, s86
  s_add_u32 s95, s95, 117240
  v_sub_u32 v88, s95, v88
  s_waitcnt lgkmcnt(0)
  v_cmp_gt_u32 vcc, 5, v29
  s_cbranch_vccnz L_sp_84
L_sd_85:
  ds_read_b64 v[80:81], v88 offset:1536
  ds_read_b64 v[82:83], v88 offset:1024
  ds_read_b64 v[84:85], v88 offset:512
  ds_read_b64 v[86:87], v88 offset:0
  s_lshl_b32 s95, s43, 13
  s_lshl_b32 s86, s42, 14
  s_sub_u32 s95, s95, s86
  s_add_u32 s95, s95, 140288
  v_add_u32 v89, s95, v5
  s_lshl_b32 s95, s43, 4
  s_lshr_b32 s94, s94, s95
  s_lshl_b32 s94, s94, 16
  v_and_b32 v90, 3, v93
  v_lshlrev_b32 v90, 4, v90
  v_lshrrev_b32 v93, 2, v93
  v_lshl_add_u32 v90, v93, 7, v90
  v_and_b32 v93, 1, v94
  v_lshl_add_u32 v90, v93, 9, v90
  v_lshrrev_b32 v93, 1, v94
  v_lshl_add_u32 v90, v93, 6, v90
  v_lshlrev_b32 v93, 26, v94
  v_lshl_add_u32 v91, v4, 11, v93
  s_lshl_b32 s86, s7, 5
  s_add_u32 s86, s86, s8
  s_lshl1_add_u32 s86, s86, s43
  s_lshl1_add_u32 s95, s86, s42
  s_lshl_b32 s95, s95, 11
  s_add_u32 s95, s95, 25165824
  s_lshl_b32 s86, s86, 2
  s_add_u32 s86, s86, 28573696
  v_mov_b32 v93, s42
  v_lshl_add_u32 v91, v93, 15, v91
  s_waitcnt lgkmcnt(0)
  v_and_b32 v64, s0, v81
  v_lshlrev_b32 v65, 16, v81
  v_and_b32 v66, s0, v80
  v_lshlrev_b32 v67, 16, v80
  v_and_b32 v68, s0, v83
  v_lshlrev_b32 v69, 16, v83
  v_and_b32 v70, s0, v82
  v_lshlrev_b32 v71, 16, v82
  v_and_b32 v72, s0, v85
  v_lshlrev_b32 v73, 16, v85
  v_and_b32 v74, s0, v84
  v_lshlrev_b32 v75, 16, v84
  v_and_b32 v76, s0, v87
  v_lshlrev_b32 v77, 16, v87
  v_and_b32 v78, s0, v86
  v_lshlrev_b32 v79, 16, v86
  v_mul_f32 v64, s94, v64
  v_mul_f32 v65, s94, v65
  v_mul_f32 v66, s94, v66
  v_mul_f32 v67, s94, v67
  v_mul_f32 v68, s94, v68
  v_mul_f32 v69, s94, v69
  v_mul_f32 v70, s94, v70
  v_mul_f32 v71, s94, v71
  v_mul_f32 v72, s94, v72
  v_mul_f32 v73, s94, v73
  v_mul_f32 v74, s94, v74
  v_mul_f32 v75, s94, v75
  v_mul_f32 v76, s94, v76
  v_mul_f32 v77, s94, v77
  v_mul_f32 v78, s94, v78
  v_mul_f32 v79, s94, v79
  v_cvt_pk_bf16_f32 v64, 0, v64
  v_cvt_pk_bf16_f32 v65, 0, v65
  v_cvt_pk_bf16_f32 v66, 0, v66
  v_cvt_pk_bf16_f32 v67, 0, v67
  v_cvt_pk_bf16_f32 v68, 0, v68
  v_cvt_pk_bf16_f32 v69, 0, v69
  v_cvt_pk_bf16_f32 v70, 0, v70
  v_cvt_pk_bf16_f32 v71, 0, v71
  v_cvt_pk_bf16_f32 v72, 0, v72
  v_cvt_pk_bf16_f32 v73, 0, v73
  v_cvt_pk_bf16_f32 v74, 0, v74
  v_cvt_pk_bf16_f32 v75, 0, v75
  v_cvt_pk_bf16_f32 v76, 0, v76
  v_cvt_pk_bf16_f32 v77, 0, v77
  v_cvt_pk_bf16_f32 v78, 0, v78
  v_cvt_pk_bf16_f32 v79, 0, v79
  v_mov_b32 v7, v22
  v_xor_b32 v8, 64, v22
  v_add_u32 v9, 0x10000, v22
  v_add_u32 v10, 0x10000, v8
  s_add_u32 s91, s91, 114688
  s_mov_b32 s70, 0
  s_waitcnt vmcnt(0)
  ds_write_b32 v25, v26
  v_add_u32 v26, 1, v26
  s_waitcnt lgkmcnt(0)
  s_branch L_JOIN
L_sp_1:
  s_mov_b32 s68, 0
L_sl_3:
  ds_read_b32 v28, v24 offset:0
  s_add_u32 s68, s68, 1
  s_cmp_gt_u32 s68, 0x40000
  s_waitcnt lgkmcnt(0)
  s_cbranch_scc1 L_sd_2
  v_cmp_gt_u32 vcc, 2, v28
  s_cbranch_vccnz L_sl_3
  s_branch L_sd_2
L_sp_4:
  s_mov_b32 s68, 0
L_sl_6:
  ds_read_b32 v28, v24 offset:0
  s_add_u32 s68, s68, 1
  s_cmp_gt_u32 s68, 0x40000
  s_waitcnt lgkmcnt(0)
  s_cbranch_scc1 L_sd_5
  v_cmp_gt_u32 vcc, 3, v28
  s_cbranch_vccnz L_sl_6
  s_branch L_sd_5
L_sp_7:
  s_mov_b32 s68, 0
L_sl_9:
  ds_read_b32 v28, v24 offset:0
  s_add_u32 s68, s68, 1
  s_cmp_gt_u32 s68, 0x40000
  s_waitcnt lgkmcnt(0)
  s_cbranch_scc1 L_sd_8
  v_cmp_gt_u32 vcc, 4, v28
  s_cbranch_vccnz L_sl_9
  s_branch L_sd_8
L_sp_10:
  s_mov_b32 s68, 0
L_sl_12:
  ds_read_b32 v28, v24 offset:0
  s_add_u32 s68, s68, 1
  s_cmp_gt_u32 s68, 0x40000
  s_waitcnt lgkmcnt(0)
  s_cbranch_scc1 L_sd_11
  v_cmp_gt_u32 vcc, 5, v28
  s_cbranch_vccnz L_sl_12
  s_branch L_sd_11
L_sp_13:
  s_mov_b32 s68, 0
L_sl_15:
  ds_read_b32 v28, v24 offset:0
  s_add_u32 s68, s68, 1
  s_cmp_gt_u32 s68, 0x40000
  s_waitcnt lgkmcnt(0)
  s_cbranch_scc1 L_sd_14
  v_cmp_gt_u32 vcc, 6, v28
  s_cbranch_vccnz L_sl_15
  s_branch L_sd_14
L_sp_16:
  s_mov_b32 s68, 0
L_sl_18:
  ds_read_b32 v28, v24 offset:0
  s_add_u32 s68, s68, 1
  s_cmp_gt_u32 s68, 0x40000
  s_waitcnt lgkmcnt(0)
  s_cbranch_scc1 L_sd_17
  v_cmp_gt_u32 vcc, 7, v28
  s_cbranch_vccnz L_sl_18
  s_branch L_sd_17
L_sp_19:
  s_mov_b32 s68, 0
L_sl_21:
  ds_read_b32 v28, v24 offset:0
  s_add_u32 s68, s68, 1
  s_cmp_gt_u32 s68, 0x40000
  s_waitcnt lgkmcnt(0)
  s_cbranch_scc1 L_sd_20
  v_cmp_gt_u32 vcc, 8, v28
  s_cbranch_vccnz L_sl_21
  s_branch L_sd_20
L_sp_22:
  s_mov_b32 s68, 0
L_sl_24:
  ds_read_b32 v28, v24 offset:0
  s_add_u32 s68, s68, 1
  s_cmp_gt_u32 s68, 0x40000
  s_waitcnt lgkmcnt(0)
  s_cbranch_scc1 L_sd_23
  v_cmp_gt_u32 vcc, 9, v28
  s_cbranch_vccnz L_sl_24
  s_branch L_sd_23
L_sp_25:
  s_mov_b32 s68, 0
L_sl_27:
  ds_read_b32 v28, v24 offset:0
  s_add_u32 s68, s68, 1
  s_cmp_gt_u32 s68, 0x40000
  s_waitcnt lgkmcnt(0)
  s_cbranch_scc1 L_sd_26
  v_cmp_gt_u32 vcc, 10, v28
  s_cbranch_vccnz L_sl_27
  s_branch L_sd_26
L_sp_28:
  s_mov_b32 s68, 0
L_sl_30:
  ds_read_b32 v28, v24 offset:0
  s_add_u32 s68, s68, 1
  s_cmp_gt_u32 s68, 0x40000
  s_waitcnt lgkmcnt(0)
  s_cbranch_scc1 L_sd_29
  v_cmp_gt_u32 vcc, 11, v28
  s_cbranch_vccnz L_sl_30
  s_branch L_sd_29
L_sp_31:
  s_mov_b32 s68, 0
L_sl_33:
  ds_read_b32 v28, v24 offset:0
  s_add_u32 s68, s68, 1
  s_cmp_gt_u32 s68, 0x40000
  s_waitcnt lgkmcnt(0)
  s_cbranch_scc1 L_sd_32
  v_cmp_gt_u32 vcc, 12, v28
  s_cbranch_vccnz L_sl_33
  s_branch L_sd_32
L_sp_34:
  s_mov_b32 s68, 0
L_sl_36:
  ds_read_b32 v28, v24 offset:0
  s_add_u32 s68, s68, 1
  s_cmp_gt_u32 s68, 0x40000
  s_waitcnt lgkmcnt(0)
  s_cbranch_scc1 L_sd_35
  v_cmp_gt_u32 vcc, 13, v28
  s_cbranch_vccnz L_sl_36
  s_branch L_sd_35
L_sp_37:
  s_mov_b32 s68, 0
L_sl_39:
  ds_read_b32 v28, v24 offset:0
  s_add_u32 s68, s68, 1
  s_cmp_gt_u32 s68, 0x40000
  s_waitcnt lgkmcnt(0)
  s_cbranch_scc1 L_sd_38
  v_cmp_gt_u32 vcc, 14, v28
  s_cbranch_vccnz L_sl_39
  s_branch L_sd_38
L_sp_40:
  s_mov_b32 s68, 0
L_sl_42:
  ds_read_b32 v28, v24 offset:0
  s_add_u32 s68, s68, 1
  s_cmp_gt_u32 s68, 0x40000
  s_waitcnt lgkmcnt(0)
  s_cbranch_scc1 L_sd_41
  v_cmp_gt_u32 vcc, 15, v28
  s_cbranch_vccnz L_sl_42
  s_branch L_sd_41
L_sp_43:
  s_mov_b32 s68, 0
L_sl_45:
  ds_read_b32 v28, v24 offset:0
  s_add_u32 s68, s68, 1
  s_cmp_gt_u32 s68, 0x40000
  s_waitcnt lgkmcnt(0)
  s_cbranch_scc1 L_sd_44
  v_cmp_gt_u32 vcc, 16, v28
  s_cbranch_vccnz L_sl_45
  s_branch L_sd_44
L_sp_46:
  s_mov_b32 s68, 0
L_sl_48:
  ds_read_b32 v28, v24 offset:0
  s_add_u32 s68, s68, 1
  s_cmp_gt_u32 s68, 0x40000
  s_waitcnt lgkmcnt(0)
  s_cbranch_scc1 L_sd_47
  v_cmp_gt_u32 vcc, 17, v28
  s_cbranch_vccnz L_sl_48
  s_branch L_sd_47
L_np_49:
  s_mov_b32 s68, 0
L_nl_51:
  ds_read_b64 v[30:31], v35
  s_add_u32 s68, s68, 1
  s_cmp_gt_u32 s68, 0x40000
  s_waitcnt lgkmcnt(0)
  s_cbranch_scc1 L_nd_50
  v_cmp_eq_u32 vcc, 0, v30
  s_cbranch_vccnz L_nl_51
  s_branch L_nd_50
L_sp_52:
  s_mov_b32 s68, 0
L_sl_54:
  ds_read_b32 v29, v24 offset:16
  s_add_u32 s68, s68, 1
  s_cmp_gt_u32 s68, 0x40000
  s_waitcnt lgkmcnt(0)
  s_cbranch_scc1 L_sd_53
  v_cmp_gt_u32 vcc, 3, v29
  s_cbranch_vccnz L_sl_54
  s_branch L_sd_53
L_sp_55:
  s_mov_b32 s68, 0
L_sl_57:
  ds_read_b32 v29, v24 offset:16
  s_add_u32 s68, s68, 1
  s_cmp_gt_u32 s68, 0x40000
  s_waitcnt lgkmcnt(0)
  s_cbranch_scc1 L_sd_56
  v_cmp_gt_u32 vcc, 5, v29
  s_cbranch_vccnz L_sl_57
  s_branch L_sd_56
L_sp_59:
  s_mov_b32 s68, 0
L_sl_61:
  ds_read_b32 v28, v24 offset:0
  s_add_u32 s68, s68, 1
  s_cmp_gt_u32 s68, 0x40000
  s_waitcnt lgkmcnt(0)
  s_cbranch_scc1 L_sd_60
  v_cmp_gt_u32 vcc, 1, v28
  s_cbranch_vccnz L_sl_61
  s_branch L_sd_60
L_sp_62:
  s_mov_b32 s68, 0
L_sl_64:
  ds_read_b32 v28, v24 offset:0
  s_add_u32 s68, s68, 1
  s_cmp_gt_u32 s68, 0x40000
  s_waitcnt lgkmcnt(0)
  s_cbranch_scc1 L_sd_63
  v_cmp_gt_u32 vcc, 18, v28
  s_cbranch_vccnz L_sl_64
  s_branch L_sd_63
L_sp_65:
  s_mov_b32 s68, 0
L_sl_67:
  ds_read_b32 v29, v24 offset:0
  s_add_u32 s68, s68, 1
  s_cmp_gt_u32 s68, 0x40000
  s_waitcnt lgkmcnt(0)
  s_cbranch_scc1 L_sd_66
  v_cmp_gt_u32 vcc, 20, v29
  s_cbranch_vccnz L_sl_67
  s_branch L_sd_66
L_sp_68:
  s_mov_b32 s68, 0
L_sl_70:
  ds_read_b32 v28, v24 offset:16
  s_add_u32 s68, s68, 1
  s_cmp_gt_u32 s68, 0x40000
  s_waitcnt lgkmcnt(0)
  s_cbranch_scc1 L_sd_69
  v_cmp_gt_u32 vcc, 9, v28
  s_cbranch_vccnz L_sl_70
  s_branch L_sd_69
L_sp_71:
  s_mov_b32 s68, 0
L_sl_73:
  ds_read_b32 v29, v25 offset:32
  ds_read_b128 v[44:47], v20
  ds_read_b128 v[48:51], v20 offset:1024
  ds_read_b32 v52, v1 offset:2048
  s_add_u32 s68, s68, 1
  s_cmp_gt_u32 s68, 0x40000
  s_waitcnt lgkmcnt(0)
  s_cbranch_scc1 L_sd_72
  v_cmp_gt_u32 vcc, 64, v29
  s_cbranch_vccnz L_sl_73
  s_branch L_sd_72
L_sp_74:
  s_mov_b32 s68, 0
L_sl_76:
  ds_read_b32 v28, v24 offset:0
  ds_read_b128 v[112:115], v12 offset:0
  ds_read_b128 v[116:119], v12 offset:1024
  ds_read_b128 v[120:123], v12 offset:2048
  ds_read_b128 v[124:127], v12 offset:3072
  s_add_u32 s68, s68, 1
  s_cmp_gt_u32 s68, 0x40000
  s_waitcnt lgkmcnt(0)
  s_cbranch_scc1 L_sd_75
  v_cmp_gt_u32 vcc, 22, v28
  s_cbranch_vccnz L_sl_76
  s_branch L_sd_75
L_rpB2_3:
  s_waitcnt lgkmcnt(0)
  s_xor_b64 s[66:67], s[16:17], s[64:65]
  s_xor_b64 s[76:77], s[18:19], s[64:65]
  s_or_b64 s[66:67], s[66:67], s[76:77]
  s_xor_b64 s[76:77], s[20:21], s[64:65]
  s_or_b64 s[66:67], s[66:67], s[76:77]
  s_xor_b64 s[76:77], s[22:23], s[64:65]
  s_or_b64 s[66:67], s[66:67], s[76:77]
  s_xor_b64 s[76:77], s[24:25], s[64:65]
  s_or_b64 s[66:67], s[66:67], s[76:77]
  s_xor_b64 s[76:77], s[26:27], s[64:65]
  s_or_b64 s[66:67], s[66:67], s[76:77]
  s_xor_b64 s[76:77], s[28:29], s[64:65]
  s_or_b64 s[66:67], s[66:67], s[76:77]
  s_cbranch_scc0 L_rgB2_3
  s_mov_b32 s68, 0
L_rlB2_3:
  s_load_dwordx16 s[16:31], s[72:73], s93 offset:1792 glc
  s_add_u32 s68, s68, 1
  s_cmp_gt_u32 s68, 0x20000
  s_waitcnt lgkmcnt(0)
  s_cbranch_scc1 L_rgB2_3
  s_xor_b64 s[66:67], s[16:17], s[64:65]
  s_xor_b64 s[76:77], s[18:19], s[64:65]
  s_or_b64 s[66:67], s[66:67], s[76:77]
  s_xor_b64 s[76:77], s[20:21], s[64:65]
  s_or_b64 s[66:67], s[66:67], s[76:77]
  s_xor_b64 s[76:77], s[22:23], s[64:65]
  s_or_b64 s[66:67], s[66:67], s[76:77]
  s_xor_b64 s[76:77], s[24:25], s[64:65]
  s_or_b64 s[66:67], s[66:67], s[76:77]
  s_xor_b64 s[76:77], s[26:27], s[64:65]
  s_or_b64 s[66:67], s[66:67], s[76:77]
  s_xor_b64 s[76:77], s[28:29], s[64:65]
  s_or_b64 s[66:67], s[66:67], s[76:77]
  s_cbranch_scc1 L_rlB2_3
  s_branch L_rgB2_3
L_rpP_7:
  s_waitcnt lgkmcnt(0)
  s_xor_b64 s[66:67], s[70:71], s[64:65]
  s_cbranch_scc0 L_rgP_7
  s_mov_b32 s68, 0
L_rlP_7:
  s_load_dwordx2 s[70:71], s[72:73], s97 offset:0 glc
  s_add_u32 s68, s68, 1
  s_cmp_gt_u32 s68, 0x20000
  s_waitcnt lgkmcnt(0)
  s_cbranch_scc1 L_rgP_7
  s_xor_b64 s[66:67], s[70:71], s[64:65]
  s_cbranch_scc1 L_rlP_7
  s_branch L_rgP_7
L_np_77:
  s_mov_b32 s68, 0
L_nl_79:
  ds_read_b64 v[30:31], v35
  s_add_u32 s68, s68, 1
  s_cmp_gt_u32 s68, 0x40000
  s_waitcnt lgkmcnt(0)
  s_cbranch_scc1 L_nd_78
  v_cmp_eq_u32 vcc, 0, v30
  s_cbranch_vccnz L_nl_79
  s_branch L_nd_78
L_sp_81:
  s_mov_b32 s68, 0
L_sl_83:
  s_sleep 8
  ds_read_b32 v28, v24 offset:16
  s_add_u32 s68, s68, 1
  s_cmp_gt_u32 s68, 0x40000
  s_waitcnt lgkmcnt(0)
  s_cbranch_scc1 L_sd_82
  v_cmp_gt_u32 vcc, 5, v28
  s_cbranch_vccnz L_sl_83
  s_branch L_sd_82
L_sp_84:
  s_mov_b32 s68, 0
L_sl_86:
  ds_read_b32 v29, v24 offset:16
  s_add_u32 s68, s68, 1
  s_cmp_gt_u32 s68, 0x40000
  s_waitcnt lgkmcnt(0)
  s_cbranch_scc1 L_sd_85
  v_cmp_gt_u32 vcc, 5, v29
  s_cbranch_vccnz L_sl_86
  s_branch L_sd_85
L_sp_89:
  s_mov_b32 s68, 0
L_sl_91:
  ds_read_b32 v28, v24 offset:0
  s_add_u32 s68, s68, 1
  s_cmp_gt_u32 s68, 0x40000
  s_waitcnt lgkmcnt(0)
  s_cbranch_scc1 L_sd_90
  v_cmp_gt_u32 vcc, 1, v28
  s_cbranch_vccnz L_sl_91
  s_branch L_sd_90
L_np_92:
  s_mov_b32 s68, 0
L_nl_94:
  global_load_dwordx2 v[30:31], v3, s[38:39] sc1
  s_add_u32 s68, s68, 1
  s_cmp_gt_u32 s68, 0x20000
  s_waitcnt vmcnt(0)
  s_cbranch_scc1 L_nd_93
  v_cmp_eq_u32 vcc, 0, v30
  s_cbranch_vccnz L_nl_94
  s_branch L_nd_93
L_sp_96:
  s_mov_b32 s68, 0
L_sl_98:
  ds_read_b32 v28, v24 offset:0
  s_add_u32 s68, s68, 1
  s_cmp_gt_u32 s68, 0x40000
  s_waitcnt lgkmcnt(0)
  s_cbranch_scc1 L_sd_97
  v_cmp_gt_u32 vcc, 3, v28
  s_cbranch_vccnz L_sl_98
  s_branch L_sd_97
L_pp_100:
  s_mov_b32 s68, 0
L_pl_102:
  s_load_dwordx16 s[80:95], s[72:73], s76 glc
  s_add_u32 s68, s68, 1
  s_cmp_gt_u32 s68, 0x20000
  s_waitcnt lgkmcnt(0)
  s_cbranch_scc1 L_pd_101
  s_xor_b64 s[66:67], s[80:81], s[64:65]
  s_xor_b64 s[82:83], s[82:83], s[64:65]
  s_or_b64 s[66:67], s[66:67], s[82:83]
  s_xor_b64 s[84:85], s[84:85], s[64:65]
  s_or_b64 s[66:67], s[66:67], s[84:85]
  s_xor_b64 s[86:87], s[86:87], s[64:65]
  s_or_b64 s[66:67], s[66:67], s[86:87]
  s_xor_b64 s[88:89], s[88:89], s[64:65]
  s_or_b64 s[66:67], s[66:67], s[88:89]
  s_xor_b64 s[90:91], s[90:91], s[64:65]
  s_or_b64 s[66:67], s[66:67], s[90:91]
  s_xor_b64 s[92:93], s[92:93], s[64:65]
  s_or_b64 s[66:67], s[66:67], s[92:93]
  s_xor_b64 s[94:95], s[94:95], s[64:65]
  s_or_b64 s[66:67], s[66:67], s[94:95]
  s_cbranch_scc1 L_pl_102
  s_branch L_pd_101
L_sf_103:
  v_mov_b32 v8, 2.0
  s_waitcnt vmcnt(0)
  s_branch L_sb_104
L_sp_106:
  s_mov_b32 s68, 0
L_sl_108:
  ds_read_b32 v28, v23 offset:0
  s_add_u32 s68, s68, 1
  s_cmp_gt_u32 s68, 0x40000
  s_waitcnt lgkmcnt(0)
  s_cbranch_scc1 L_sd_107
  v_cmp_gt_u32 vcc, 11, v28
  s_cbranch_vccnz L_sl_108
  s_branch L_sd_107
L_ip_109:
  s_mov_b32 s68, 0
L_il_111:
  buffer_load_dwordx4 v[64:67], v5, s[72:75], s71 offen sc1
  buffer_load_dwordx4 v[68:71], v5, s[72:75], s98 offen sc1
  buffer_load_dwordx4 v[72:75], v5, s[72:75], s99 offen sc1
  s_add_u32 s68, s68, 1
  s_cmp_gt_u32 s68, 0x8000
  s_waitcnt vmcnt(0)
  s_cbranch_scc1 L_id_110
  v_xor_b32 v74, s64, v67
  v_xor_b32 v67, s64, v71
  v_xor_b32 v71, s64, v75
  v_or3_b32 v74, v74, v67, v71
  v_cmp_ne_u32 vcc, 0, v74
  s_cbranch_vccnz L_il_111
  s_branch L_id_110
L_sp_112:
  s_mov_b32 s68, 0
L_sl_114:
  ds_read_b32 v28, v24 offset:0
  s_add_u32 s68, s68, 1
  s_cmp_gt_u32 s68, 0x40000
  s_waitcnt lgkmcnt(0)
  s_cbranch_scc1 L_sd_113
  v_cmp_gt_u32 vcc, 5, v28
  s_cbranch_vccnz L_sl_114
  s_branch L_sd_113
L_sp_115:
  s_mov_b32 s68, 0
L_sl_117:
  ds_read_b32 v28, v23 offset:0
  s_add_u32 s68, s68, 1
  s_cmp_gt_u32 s68, 0x40000
  s_waitcnt lgkmcnt(0)
  s_cbranch_scc1 L_sd_116
  v_cmp_gt_u32 vcc, 19, v28
  s_cbranch_vccnz L_sl_117
  s_branch L_sd_116
L_sp_118:
  s_mov_b32 s68, 0
L_sl_120:
  ds_read_b32 v28, v23 offset:0
  s_add_u32 s68, s68, 1
  s_cmp_gt_u32 s68, 0x40000
  s_waitcnt lgkmcnt(0)
  s_cbranch_scc1 L_sd_119
  v_cmp_gt_u32 vcc, 20, v28
  s_cbranch_vccnz L_sl_120
  s_branch L_sd_119
L_sp_121:
  s_mov_b32 s68, 0
L_sl_123:
  ds_read_b32 v29, v24 offset:0
  s_add_u32 s68, s68, 1
  s_cmp_gt_u32 s68, 0x40000
  s_waitcnt lgkmcnt(0)
  s_cbranch_scc1 L_sd_122
  v_cmp_gt_u32 vcc, 6, v29
  s_cbranch_vccnz L_sl_123
  s_branch L_sd_122
L_sp_124:
  s_mov_b32 s68, 0
L_sl_126:
  ds_read_b32 v29, v23 offset:0
  s_add_u32 s68, s68, 1
  s_cmp_gt_u32 s68, 0x40000
  s_waitcnt lgkmcnt(0)
  s_cbranch_scc1 L_sd_125
  v_cmp_gt_u32 vcc, 21, v29
  s_cbranch_vccnz L_sl_126
  s_branch L_sd_125
L_sp_127:
  s_mov_b32 s68, 0
L_sl_129:
  ds_read_b32 v28, v24 offset:0
  s_add_u32 s68, s68, 1
  s_cmp_gt_u32 s68, 0x40000
  s_waitcnt lgkmcnt(0)
  s_cbranch_scc1 L_sd_128
  v_cmp_gt_u32 vcc, 8, v28
  s_cbranch_vccnz L_sl_129
  s_branch L_sd_128
L_gp_130:
  s_mov_b32 s68, 0
L_gl_132:
  buffer_load_dwordx2 v[32:33], v21, s[72:75], s45 offen sc1
  s_add_u32 s68, s68, 1
  s_cmp_gt_u32 s68, 0x40000
  s_waitcnt vmcnt(0)
  s_cbranch_scc1 L_gd_131
  v_cmp_ne_u32 vcc, s64, v33
  s_cbranch_vccnz L_gl_132
  s_branch L_gd_131
L_sp_133:
  s_mov_b32 s68, 0
L_sl_135:
  ds_read_b32 v28, v24 offset:0
  s_add_u32 s68, s68, 1
  s_cmp_gt_u32 s68, 0x40000
  s_waitcnt lgkmcnt(0)
  s_cbranch_scc1 L_sd_134
  v_cmp_gt_u32 vcc, 10, v28
  s_cbranch_vccnz L_sl_135
  s_branch L_sd_134
L_rpA_14:
  s_waitcnt lgkmcnt(0)
  s_xor_b64 s[66:67], s[16:17], s[64:65]
  s_xor_b64 s[96:97], s[18:19], s[64:65]
  s_or_b64 s[66:67], s[66:67], s[96:97]
  s_xor_b64 s[96:97], s[20:21], s[64:65]
  s_or_b64 s[66:67], s[66:67], s[96:97]
  s_xor_b64 s[96:97], s[22:23], s[64:65]
  s_or_b64 s[66:67], s[66:67], s[96:97]
  s_xor_b64 s[96:97], s[24:25], s[64:65]
  s_or_b64 s[66:67], s[66:67], s[96:97]
  s_xor_b64 s[96:97], s[26:27], s[64:65]
  s_or_b64 s[66:67], s[66:67], s[96:97]
  s_xor_b64 s[96:97], s[28:29], s[64:65]
  s_or_b64 s[66:67], s[66:67], s[96:97]
  s_cbranch_scc0 L_rgA_14
  s_mov_b32 s68, 0
L_rlA_14:
  s_load_dwordx16 s[16:31], s[72:73], s61 offset:1536 glc
  s_add_u32 s68, s68, 1
  s_cmp_gt_u32 s68, 0x20000
  s_waitcnt lgkmcnt(0)
  s_cbranch_scc1 L_rgA_14
  s_xor_b64 s[66:67], s[16:17], s[64:65]
  s_xor_b64 s[96:97], s[18:19], s[64:65]
  s_or_b64 s[66:67], s[66:67], s[96:97]
  s_xor_b64 s[96:97], s[20:21], s[64:65]
  s_or_b64 s[66:67], s[66:67], s[96:97]
  s_xor_b64 s[96:97], s[22:23], s[64:65]
  s_or_b64 s[66:67], s[66:67], s[96:97]
  s_xor_b64 s[96:97], s[24:25], s[64:65]
  s_or_b64 s[66:67], s[66:67], s[96:97]
  s_xor_b64 s[96:97], s[26:27], s[64:65]
  s_or_b64 s[66:67], s[66:67], s[96:97]
  s_xor_b64 s[96:97], s[28:29], s[64:65]
  s_or_b64 s[66:67], s[66:67], s[96:97]
  s_cbranch_scc1 L_rlA_14
  s_branch L_rgA_14
L_exit:
  s_endpgm
.section .rodata,"a"
.p2align 6
.amdhsa_kernel gated_mix__ssm_conv_h3__dense_activation_silu__prompt_kernel
  .amdhsa_next_free_vgpr 256
  .amdhsa_next_free_sgpr 102
  .amdhsa_accum_offset 128
  .amdhsa_group_segment_fixed_size 0
  .amdhsa_kernarg_size 104
  .amdhsa_user_sgpr_count 2
  .amdhsa_user_sgpr_kernarg_segment_ptr 1
  .amdhsa_system_sgpr_workgroup_id_x 1
  .amdhsa_float_denorm_mode_32 3
.end_amdhsa_kernel
```
